```python
import torch

def _softmax(x, axis=-1):
    return torch.softmax(x, dim=axis)
def _gelu(x):
    return torch.nn.functional.gelu(x, approximate="tanh")
def _silu(x):
    return torch.nn.functional.silu(x)
def _sigmoid(x):
    return torch.sigmoid(x)
def _layernorm(x, axis=-1, eps=1e-5):
    m = x.mean(dim=axis, keepdim=True)
    v = x.var(dim=axis, keepdim=True, unbiased=False)
    return (x - m) / torch.sqrt(v + eps)
def _scatter_add(tgt, idx, src, axis=0):
    return tgt.clone().index_add_(axis, idx, src)
def _segment_sum(src, seg, n):
    out = torch.zeros((n,) + src.shape[1:], dtype=src.dtype)
    return out.index_add_(0, seg, src)
def _pad(x, pw):
    flat = tuple(v for pair in reversed(pw) for v in pair)
    return torch.nn.functional.pad(x, flat)

kernel_name = 'concat_heads__ssm_conv_s4d__linear_attn_block__prompt'

def setup_inputs():

    _w = (lambda a: (lambda t: t.to(torch.bfloat16) if t.is_floating_point() else t)(torch.as_tensor(a)))
    def _A_setup():
        Bsz, L, D, N = 1, 2048, 640, 128
        return {
            "u": _w((lambda *s: torch.randn(*s, dtype=torch.bfloat16) * 0.05)(Bsz, L, D)),
            "log_A_real": _w((lambda *s: torch.randn(*s, dtype=torch.bfloat16) * 3.2)(D, N) * 0.5),
            "A_imag": _w((lambda *s: torch.randn(*s, dtype=torch.bfloat16) * 0.05)(D, N) * 3.14),
            "C_real": _w((lambda *s: torch.randn(*s, dtype=torch.bfloat16) * 0.2)(D, N) / N ** 0.5),
            "C_imag": _w((lambda *s: torch.randn(*s, dtype=torch.bfloat16) * 0.2)(D, N) / N ** 0.5),
            "log_dt": _w((lambda *s: torch.randn(*s, dtype=torch.bfloat16) * 0.05)(D) * 0.5 - 4.0),
            "D_skip": _w((lambda *s: torch.randn(*s, dtype=torch.bfloat16) * 0.05)(D)),
        }
    _A_in = _A_setup()

    def _B_setup():
        B, S, D = 1, 2048, 640
        return {
            "x": _w((lambda *s: torch.randn(*s, dtype=torch.bfloat16) * 0.05)(B, S, D)),
            "wqkv": _w((lambda *s: torch.randn(*s, dtype=torch.bfloat16) * 0.4)(D, 3 * D)),
            "wo": _w((lambda *s: torch.randn(*s, dtype=torch.bfloat16) * 0.05)(D, D)),
        }
    _B_in = _B_setup()

    return {
        "A_u": _A_in["u"],
        "A_log_A_real": _A_in["log_A_real"],
        "A_A_imag": _A_in["A_imag"],
        "A_C_real": _A_in["C_real"],
        "A_C_imag": _A_in["C_imag"],
        "A_log_dt": _A_in["log_dt"],
        "A_D_skip": _A_in["D_skip"],
        "B_x": _B_in["x"],
        "B_wqkv": _B_in["wqkv"],
        "B_wo": _B_in["wo"],
    }

def reference(A_u, A_log_A_real, A_A_imag, A_C_real, A_C_imag, A_log_dt, A_D_skip, B_x, B_wqkv, B_wo):
    def _A_ref(u, log_A_real, A_imag, C_real, C_imag, log_dt, D_skip):
        L = u.shape[1]
        dt = torch.exp(log_dt)
        A = -torch.exp(log_A_real) + 1j * A_imag
        C = (C_real + 1j * C_imag) * dt[:, None]
        pos = (lambda x, dt: x.to(dt))(torch.arange(L), log_dt.dtype)
        P = torch.exp((A * dt[:, None])[:, :, None] * pos[None, None, :])
        K = 2.0 * torch.einsum("dn,dnl->dl", C, P).real
        L2 = 2 * L
        u_t = (lambda x, *d: x.permute(*d))(u, 0, 2, 1)
        Kf = (lambda x, *a, **k: torch.fft.rfft(x.float(), *a, **k))(K, L2)
        Uf = (lambda x, *a, **k: torch.fft.rfft(x.float(), *a, **k))(u_t, L2)
        y = (lambda x, *a, **k: torch.fft.irfft(x, *a, **k).to(torch.bfloat16))(Uf * Kf[None, :, :], L2)[:, :, :L]
        y = (lambda x, *d: x.permute(*d))(y, 0, 2, 1)
        return y + u * D_skip[None, None, :]

    def _B_ref(x, wqkv, wo):
        B, S, D = x.shape
        H = 32; Dh = D // H
        qkv = (lambda x, *d: x.permute(*d))((x @ wqkv).reshape(B, S, 3, H, Dh), 2, 0, 3, 1, 4)
        q, k, v = qkv[0], qkv[1], qkv[2]
        phi = lambda t: torch.where(t > 0, t + 1, torch.exp(t)) + 1e-6
        pq, pk = phi(q), phi(k)
        kv = torch.einsum("bhsd,bhse->bhde", pk, v)
        z = torch.einsum("bhsd->bhd", pk)
        num = torch.einsum("bhqd,bhde->bhqe", pq, kv)
        den = torch.einsum("bhqd,bhd->bhq", pq, z)[..., None] + 1e-6
        o = num / den
        return (lambda x, *d: x.permute(*d))(o, 0, 2, 1, 3).reshape(B, S, D) @ wo

    a = _A_ref(A_u, A_log_A_real, A_A_imag, A_C_real, A_C_imag, A_log_dt, A_D_skip)
    b = _B_ref(B_x, B_wqkv, B_wo)
    return torch.concatenate([a, b], axis=-1)
```

```asm
; @launch grid=(256,1,1) block=(512,1,1) lds=163840
.amdgcn_target "amdgcn-amd-amdhsa--gfx950"
.text
Lcode_start:
.globl concat_heads__ssm_conv_s4d__linear_attn_block__prompt_kernel
.p2align 8
.type concat_heads__ssm_conv_s4d__linear_attn_block__prompt_kernel,@function
concat_heads__ssm_conv_s4d__linear_attn_block__prompt_kernel:
s_cmp_ge_u32 s2, 256
s_cbranch_scc1 Lend
s_load_dwordx16 s[16:31], s[0:1], 0
s_load_dwordx8 s[32:39], s[0:1], 64
s_load_dwordx2 s[40:41], s[0:1], 96
v_lshrrev_b32 v2, 6, v0
v_and_b32 v1, 63, v0
s_cmp_ge_u32 s2, 16
s_cbranch_scc1 Lnopf_1
s_getpc_b64 s[64:65]
Lpc_1:
s_sub_u32 s64, s64, Lpc_1-Lcode_start
s_subb_u32 s65, s65, 0
v_lshlrev_b32 v3, 7, v0
v_min_u32 v3, Lcode_end-Lcode_start-4, v3
global_load_dword v159, v3, s[64:65]
Lnopf_1:
v_readfirstlane_b32 s3, v2
s_mov_b32 s66, 3670016
s_and_b32 s44, s2, 7
s_lshr_b32 s45, s2, 3
s_add_u32 s45, s45, 24
s_and_b32 s45, s45, 31
s_cmp_ge_u32 s45, 24
s_cbranch_scc1 LA_from1
s_and_b32 s46, s44, 3
s_lshl_b32 s46, s46, 2
s_and_b32 s53, s45, 3
s_add_u32 s46, s46, s53
s_lshr_b32 s47, s45, 2
s_lshr_b32 s48, s44, 2
s_cmp_ge_u32 s47, 4
s_cselect_b32 s63, 1, 0
s_cselect_b32 s51, 0, 1120
s_cselect_b32 s55, 0, 1280
s_cselect_b32 s49, 1, 2
s_lshl_b32 s54, 160, s63
s_lshl_b32 s49, s48, s49
s_and_b32 s50, s47, 3
s_add_u32 s49, s49, s50
s_mul_i32 s50, s49, s54
s_add_u32 s50, s50, s55
s_cmp_lt_u32 s45, 12
s_cselect_b32 s42, 0, 16
s_cmp_ge_u32 s45, 16
s_cselect_b32 s42, 4, s42
s_add_u32 s45, s45, s42
s_mul_i32 s42, s44, 48
s_lshl_b32 s52, s45, 2
s_add_u32 s42, s42, s52
s_add_u32 s42, s42, 176
s_cmp_lt_u32 s3, 4
s_cbranch_scc1 LG1_comp
s_sub_u32 s52, s3, 4
s_mul_i32 s53, s53, 5
s_lshr_b32 s53, s53, 1
s_lshl_b32 s54, s47, 2
s_lshr_b32 s54, 0x875320, s54
s_and_b32 s54, s54, 15
s_add_u32 s53, s53, s54
s_add_u32 s53, s53, s44
s_mul_i32 s54, s53, 26
s_lshr_b32 s54, s54, 8
s_mul_i32 s54, s54, 10
s_sub_u32 s64, s53, s54
v_lshrrev_b32 v2, 3, v1
v_lshrrev_b32 v3, 4, v1
v_and_b32 v4, 7, v1
v_xor_b32 v3, v3, v4
v_mul_u32_u24 v2, 1280, v2
v_lshl_add_u32 v13, v3, 4, v2
v_xor_b32 v14, 64, v13
v_add_u32 v14, 10240, v14
s_lshl_b32 s65, s46, 2
s_add_u32 s65, s65, s52
s_mul_i32 s65, s65, 40960
s_lshl_b32 s53, s52, 12
s_add_u32 s53, s53, 20480
s_mov_b32 s56, 0
s_mov_b32 s57, 0
s_lshl_b32 s66, s64, 7
s_add_u32 s66, s66, s65
s_add_u32 s67, s66, 20480
s_add_u32 s58, s53, s57
s_waitcnt lgkmcnt(0)
s_mov_b32 s68, s30
s_mov_b32 s69, s31
s_mov_b32 s70, 2621440
s_mov_b32 s71, 0x20000
s_add_u32 m0, s58, 0
s_nop 0
buffer_load_dwordx4 v13, s[68:71], s66 offen lds
s_add_u32 m0, s58, 1024
s_nop 0
buffer_load_dwordx4 v14, s[68:71], s66 offen lds
s_add_u32 m0, s58, 2048
s_nop 0
buffer_load_dwordx4 v13, s[68:71], s67 offen lds
s_add_u32 m0, s58, 3072
s_nop 0
buffer_load_dwordx4 v14, s[68:71], s67 offen lds
s_mul_i32 s54, s52, 61440
s_add_u32 s50, s50, s54
v_mov_b32 v7, s51
s_movk_i32 s54, 3840
s_movk_i32 s55, -320
v_and_b32 v15, 32, v1
v_add_u32 v8, 0, v1
v_mul_u32_u24 v16, 3277, v8
v_lshlrev_b32 v8, 4, v8
v_lshrrev_b32 v16, 16, v16
v_mad_i32_i24 v8, v16, s55, v8
v_cmp_le_u32 vcc, 160, v8
v_mad_u32_u24 v8, v16, s54, v8
v_add_u32 v6, v8, v7
v_cndmask_b32 v8, v8, v6, vcc
v_add_u32 v9, 64, v1
v_mul_u32_u24 v17, 3277, v9
v_lshlrev_b32 v9, 4, v9
v_lshrrev_b32 v17, 16, v17
v_mad_i32_i24 v9, v17, s55, v9
v_cmp_le_u32 vcc, 160, v9
v_mad_u32_u24 v9, v17, s54, v9
v_add_u32 v6, v9, v7
v_cndmask_b32 v9, v9, v6, vcc
v_add_u32 v10, 128, v1
v_mul_u32_u24 v18, 3277, v10
v_lshlrev_b32 v10, 4, v10
v_lshrrev_b32 v18, 16, v18
v_mad_i32_i24 v10, v18, s55, v10
v_xor_b32 v10, v10, v15
v_cmp_le_u32 vcc, 160, v10
v_mad_u32_u24 v10, v18, s54, v10
v_add_u32 v6, v10, v7
v_cndmask_b32 v10, v10, v6, vcc
v_add_u32 v11, 192, v1
v_mul_u32_u24 v19, 3277, v11
v_lshlrev_b32 v11, 4, v11
v_lshrrev_b32 v19, 16, v19
v_mad_i32_i24 v11, v19, s55, v11
v_xor_b32 v11, 32, v11
v_cmp_le_u32 vcc, 160, v11
v_mad_u32_u24 v11, v19, s54, v11
v_add_u32 v6, v11, v7
v_cndmask_b32 v11, v11, v6, vcc
v_add_u32 v12, 256, v1
v_mul_u32_u24 v20, 3277, v12
v_lshlrev_b32 v12, 4, v12
v_lshrrev_b32 v20, 16, v20
v_mad_i32_i24 v12, v20, s55, v12
v_xor_b32 v12, 32, v12
v_cmp_le_u32 vcc, 160, v12
v_mad_u32_u24 v12, v20, s54, v12
v_add_u32 v6, v12, v7
v_cndmask_b32 v12, v12, v6, vcc
s_mul_i32 s54, s52, 5120
s_mov_b32 s4, s32
s_mov_b32 s5, s33
s_mov_b32 s6, 2457600
s_mov_b32 s7, 0x20000
s_branch LG1_lw
LG1_ll:
s_lshl_b32 s66, s64, 7
s_add_u32 s66, s66, s65
s_add_u32 s67, s66, 20480
s_add_u32 s58, s53, s57
s_add_u32 m0, s58, 0
s_nop 0
buffer_load_dwordx4 v13, s[68:71], s66 offen lds
s_add_u32 m0, s58, 1024
s_nop 0
buffer_load_dwordx4 v14, s[68:71], s66 offen lds
s_add_u32 m0, s58, 2048
s_nop 0
buffer_load_dwordx4 v13, s[68:71], s67 offen lds
s_add_u32 m0, s58, 3072
s_nop 0
buffer_load_dwordx4 v14, s[68:71], s67 offen lds
LG1_lw:
s_mul_i32 s59, s64, 245760
s_add_u32 s59, s59, s50
s_add_u32 s60, s54, s57
s_add_u32 m0, s60, 0
s_nop 0
buffer_load_dwordx4 v8, s[4:7], s59 offen lds
s_add_u32 m0, s60, 1024
s_nop 0
buffer_load_dwordx4 v9, s[4:7], s59 offen lds
s_add_u32 m0, s60, 2048
s_nop 0
buffer_load_dwordx4 v10, s[4:7], s59 offen lds
s_add_u32 m0, s60, 3072
s_nop 0
buffer_load_dwordx4 v11, s[4:7], s59 offen lds
s_add_u32 m0, s60, 4096
s_nop 0
buffer_load_dwordx4 v12, s[4:7], s59 offen lds
s_cmp_eq_u32 s56, 0
s_cbranch_scc1 LG1_l1
s_waitcnt vmcnt(9)
s_barrier
LG1_l1:
s_add_u32 s64, s64, 1
s_cmp_eq_u32 s64, 10
s_cselect_b32 s64, 0, s64
s_add_u32 s57, s57, 40960
s_cmp_eq_u32 s57, 163840
s_cselect_b32 s57, 0, s57
s_add_u32 s56, s56, 1
s_cmp_lt_u32 s56, 10
s_cbranch_scc1 LG1_ll
s_waitcnt vmcnt(0)
s_barrier
v_mov_b32 v30, 0
s_mov_b64 exec, 1
global_load_dwordx2 v[28:29], v30, s[38:39] offset:128 sc1
s_mov_b64 exec, -1
v_lshlrev_b32 v21, 2, v1
s_mov_b64 exec, 0xff
global_load_dword v20, v21, s[38:39] sc1
s_mov_b64 exec, -1
s_mov_b32 s95, s45
v_bfe_u32 v154, v1, 2, 2
v_lshrrev_b32 v155, 5, v1
v_xor_b32 v154, v154, v155
v_lshlrev_b32 v154, 6, v154
v_and_b32 v155, 3, v1
v_lshl_add_u32 v154, v155, 4, v154
v_lshrrev_b32 v155, 4, v1
v_mul_u32_u24 v155, 1280, v155
v_add_u32 v152, v154, v155
v_xor_b32 v153, 128, v152
s_lshr_b32 s92, s95, 2
s_lshl_b32 s92, s92, 8
s_sub_u32 s93, s3, 4
s_mul_i32 s94, s93, 204800
s_add_u32 s92, s92, s94
s_mul_i32 s94, s93, 20480
s_add_u32 s94, s94, 81920
s_mov_b32 s96, s34
s_mov_b32 s97, s35
s_mov_b32 s98, 819200
s_mov_b32 s99, 0x20000
s_barrier
s_waitcnt vmcnt(0)
s_mov_b32 s67, 0
Lpl1:
v_readfirstlane_b32 s68, v28
v_readfirstlane_b32 s69, v29
s_add_u32 s67, s67, 1
s_cmp_lg_u32 s68, 0
s_cbranch_scc1 Lpe1
s_sleep 8
v_mov_b32 v30, 0
s_mov_b64 exec, 1
global_load_dwordx2 v[28:29], v30, s[38:39] offset:128 sc1
s_mov_b64 exec, -1
s_waitcnt vmcnt(0)
s_cmp_lt_u32 s67, 0x40000
s_cbranch_scc1 Lpl1
Lpe1:
s_cmp_lt_u32 s45, 20
s_cbranch_scc1 LG1_l8
s_cmp_lg_u32 s52, 2
s_cbranch_scc1 LG1_l6
v_and_b32 v18, 31, v1
v_lshlrev_b32 v18, 7, v18
s_lshr_b32 s50, s42, 6
s_lshl_b32 s50, s50, 12
s_add_u32 s50, s50, 3235840
v_add_u32 v18, s50, v18
s_mov_b32 s67, 0
Lpl2:
global_load_dwordx2 v[16:17], v18, s[40:41] sc1
s_waitcnt vmcnt(0)
Lpc2:
v_cmp_ne_u64 vcc, s[68:69], v[16:17]
s_add_u32 s67, s67, 1
s_nop 3
s_cbranch_vccz Lpe2
s_sleep 8
s_cmp_lt_u32 s67, 0x40000
s_cbranch_scc1 Lpl2
Lpe2:
s_branch LG1_l6
LG1_l8:
s_add_u32 m0, s94, 0
s_add_u32 s93, s92, 0
buffer_load_dwordx4 v152, s[96:99], s93 offen lds
s_add_u32 m0, s94, 1024
s_add_u32 s93, s92, 5120
buffer_load_dwordx4 v153, s[96:99], s93 offen lds
s_add_u32 m0, s94, 2048
s_add_u32 s93, s92, 10240
buffer_load_dwordx4 v152, s[96:99], s93 offen lds
s_add_u32 m0, s94, 3072
s_add_u32 s93, s92, 15360
buffer_load_dwordx4 v153, s[96:99], s93 offen lds
s_add_u32 m0, s94, 4096
s_add_u32 s93, s92, 20480
buffer_load_dwordx4 v152, s[96:99], s93 offen lds
s_add_u32 m0, s94, 5120
s_add_u32 s93, s92, 25600
buffer_load_dwordx4 v153, s[96:99], s93 offen lds
s_add_u32 m0, s94, 6144
s_add_u32 s93, s92, 30720
buffer_load_dwordx4 v152, s[96:99], s93 offen lds
s_add_u32 m0, s94, 7168
s_add_u32 s93, s92, 35840
buffer_load_dwordx4 v153, s[96:99], s93 offen lds
s_add_u32 m0, s94, 8192
s_add_u32 s93, s92, 40960
buffer_load_dwordx4 v152, s[96:99], s93 offen lds
s_add_u32 m0, s94, 9216
s_add_u32 s93, s92, 46080
buffer_load_dwordx4 v153, s[96:99], s93 offen lds
s_add_u32 m0, s94, 10240
s_add_u32 s93, s92, 51200
buffer_load_dwordx4 v152, s[96:99], s93 offen lds
s_add_u32 m0, s94, 11264
s_add_u32 s93, s92, 56320
buffer_load_dwordx4 v153, s[96:99], s93 offen lds
s_add_u32 m0, s94, 12288
s_add_u32 s93, s92, 61440
buffer_load_dwordx4 v152, s[96:99], s93 offen lds
s_add_u32 m0, s94, 13312
s_add_u32 s93, s92, 66560
buffer_load_dwordx4 v153, s[96:99], s93 offen lds
s_add_u32 m0, s94, 14336
s_add_u32 s93, s92, 71680
buffer_load_dwordx4 v152, s[96:99], s93 offen lds
s_add_u32 m0, s94, 15360
s_add_u32 s93, s92, 76800
buffer_load_dwordx4 v153, s[96:99], s93 offen lds
s_add_u32 m0, s94, 16384
s_add_u32 s93, s92, 81920
buffer_load_dwordx4 v152, s[96:99], s93 offen lds
s_add_u32 m0, s94, 17408
s_add_u32 s93, s92, 87040
buffer_load_dwordx4 v153, s[96:99], s93 offen lds
s_add_u32 m0, s94, 18432
s_add_u32 s93, s92, 92160
buffer_load_dwordx4 v152, s[96:99], s93 offen lds
s_add_u32 m0, s94, 19456
s_add_u32 s93, s92, 97280
buffer_load_dwordx4 v153, s[96:99], s93 offen lds
LG1_l6:
s_mov_b32 s66, 0
s_cmp_eq_u32 s63, 1
s_cbranch_scc1 LG1_r5
s_mov_b64 exec, 0xff
s_mov_b32 s67, 0
s_branch Lpc3
Lpl3:
global_load_dword v20, v21, s[38:39] sc1
s_waitcnt vmcnt(0)
Lpc3:
v_cmp_eq_u32 vcc, 0, v20
s_add_u32 s67, s67, 1
s_nop 3
s_cbranch_vccz Lpe3
s_sleep 3
s_cmp_lt_u32 s67, 0x40000
s_cbranch_scc1 Lpl3
Lpe3:
s_branch LG1_red
LG1_comp:
v_and_b32 v2, 15, v1
v_lshrrev_b32 v3, 4, v1
s_lshl_b32 s52, s46, 2
s_add_u32 s52, s52, s3
s_mul_i32 s53, s52, 40960
v_bfe_u32 v5, v1, 2, 2
v_lshl_add_u32 v5, v3, 3, v5
v_mul_u32_u24 v5, 320, v5
v_and_b32 v6, 3, v1
v_lshl_add_u32 v5, v6, 3, v5
v_and_b32 v6, 1, v3
v_lshlrev_b32 v6, 5, v6
v_add_u32 v4, v5, v6
v_sub_u32 v5, v5, v6
v_add_u32 v5, 32, v5
v_lshrrev_b32 v6, 1, v2
v_xor_b32 v6, v6, v3
v_lshlrev_b32 v6, 4, v6
v_lshl_add_u32 v6, v2, 7, v6
s_lshl_b32 s54, s3, 12
s_add_u32 s54, s54, 20480
v_add_u32 v6, s54, v6
v_xor_b32 v7, 64, v6
v_mov_b32 v8, v4
v_mov_b32 v9, v5
v_mov_b32 v10, v6
v_mov_b32 v11, v7
v_mov_b32 v12, v4
v_mov_b32 v13, v5
v_mov_b32 v16, 0
v_mov_b32 v17, 0
v_mov_b32 v18, 0
v_mov_b32 v19, 0
v_mov_b32 v20, 0
v_mov_b32 v21, 0
v_mov_b32 v22, 0
v_mov_b32 v23, 0
v_mov_b32 v24, 0
v_mov_b32 v25, 0
v_mov_b32 v26, 0
v_mov_b32 v27, 0
v_mov_b32 v28, 0
v_mov_b32 v29, 0
v_mov_b32 v30, 0
v_mov_b32 v31, 0
v_mov_b32 v32, 0
v_mov_b32 v33, 0
v_mov_b32 v34, 0
v_mov_b32 v35, 0
v_mov_b32 v36, 0
v_mov_b32 v37, 0
v_mov_b32 v38, 0
v_mov_b32 v39, 0
v_mov_b32 v40, 0
v_mov_b32 v41, 0
v_mov_b32 v42, 0
v_mov_b32 v43, 0
v_mov_b32 v44, 0
v_mov_b32 v45, 0
v_mov_b32 v46, 0
v_mov_b32 v47, 0
v_mov_b32 v48, 0
v_mov_b32 v49, 0
v_mov_b32 v50, 0
v_mov_b32 v51, 0
v_mov_b32 v52, 0
v_mov_b32 v53, 0
v_mov_b32 v54, 0
v_mov_b32 v55, 0
v_mov_b32 v56, 0
v_mov_b32 v57, 0
v_mov_b32 v58, 0
v_mov_b32 v59, 0
v_mov_b32 v60, 0
v_mov_b32 v61, 0
v_mov_b32 v62, 0
v_mov_b32 v63, 0
v_mov_b32 v64, 0
v_mov_b32 v65, 0
v_mov_b32 v66, 0
v_mov_b32 v67, 0
v_mov_b32 v68, 0
v_mov_b32 v69, 0
v_mov_b32 v70, 0
v_mov_b32 v71, 0
v_mov_b32 v72, 0
v_mov_b32 v73, 0
v_mov_b32 v74, 0
v_mov_b32 v75, 0
v_mov_b32 v76, 0
v_mov_b32 v77, 0
v_mov_b32 v78, 0
v_mov_b32 v79, 0
v_mov_b32 v80, 0
v_mov_b32 v81, 0
v_mov_b32 v82, 0
v_mov_b32 v83, 0
v_mov_b32 v84, 0
v_mov_b32 v85, 0
v_mov_b32 v86, 0
v_mov_b32 v87, 0
v_mov_b32 v88, 0
v_mov_b32 v89, 0
v_mov_b32 v90, 0
v_mov_b32 v91, 0
v_mov_b32 v92, 0
v_mov_b32 v93, 0
v_mov_b32 v94, 0
v_mov_b32 v95, 0
v_mov_b32 v216, 0x3f803f80
v_mov_b32 v217, 0x3f803f80
v_mov_b32 v218, 0x3f803f80
v_mov_b32 v219, 0x3f803f80
v_mul_u32_u24 v14, 80, v2
v_lshl_add_u32 v14, v3, 4, v14
s_mul_i32 s60, s3, 6720
s_add_u32 s60, s60, 0
v_add_u32 v14, s60, v14
s_mul_i32 s60, s3, -6720
s_add_u32 s60, s60, 26880
v_add_u32 v15, s60, v14
s_mov_b32 vcc_lo, 0xffffffff
s_mov_b32 vcc_hi, 0xffffffff
v_cndmask_b32 v220, v15, v14, vcc
s_mov_b32 vcc_lo, 0x1f001f
s_mov_b32 vcc_hi, 0x1f001f
v_cndmask_b32 v221, v15, v14, vcc
s_mov_b32 s4, 0x100010
s_mov_b32 s5, 0x100010
s_mov_b32 vcc_lo, 0xffff
s_mov_b32 vcc_hi, 0x0
v_cndmask_b32 v222, v15, v14, vcc
s_mov_b32 vcc_lo, 0xfff0001f
s_mov_b32 vcc_hi, 0xfff0fff0
v_cndmask_b32 v223, v15, v14, vcc
s_mov_b32 s6, 0x10
s_mov_b32 s7, 0x0
s_mov_b32 vcc_lo, 0x1ff0000
s_mov_b32 vcc_hi, 0x1ff01ff
v_cndmask_b32 v224, v15, v14, vcc
s_mov_b32 s8, 0x1000000
s_mov_b32 s9, 0x1000100
s_mov_b32 vcc_lo, 0xfff0fff0
s_mov_b32 vcc_hi, 0x0
v_cndmask_b32 v225, v15, v14, vcc
s_mov_b32 vcc_lo, 0x1ff01ff
s_mov_b32 vcc_hi, 0xff00ff00
v_cndmask_b32 v226, v15, v14, vcc
s_mov_b32 s10, 0x1000100
s_mov_b32 s11, 0x0
s_mov_b32 vcc_lo, 0x0
s_mov_b32 vcc_hi, 0x1fff1fff
v_cndmask_b32 v227, v15, v14, vcc
s_mov_b32 s12, 0x0
s_mov_b32 s13, 0x10001000
s_mov_b32 vcc_lo, 0xff00ff00
s_mov_b32 vcc_hi, 0xff00
v_cndmask_b32 v228, v15, v14, vcc
s_mov_b32 vcc_lo, 0x1fff1fff
s_mov_b32 vcc_hi, 0xf0001fff
v_cndmask_b32 v229, v15, v14, vcc
s_mov_b32 s14, 0x10001000
s_mov_b32 s15, 0x1000
s_mov_b32 vcc_lo, 0x0
s_mov_b32 vcc_hi, 0xffff0000
v_cndmask_b32 v230, v15, v14, vcc
s_mov_b32 vcc_lo, 0x0
s_mov_b32 vcc_hi, 0x10000
v_cndmask_b32 v231, v15, v14, vcc
s_mov_b32 vcc_lo, 0xf000f000
s_mov_b32 vcc_hi, 0xf000f000
v_cndmask_b32 v232, v15, v14, vcc
s_mov_b32 vcc_lo, 0xffffffff
s_mov_b32 vcc_hi, 0xffffffff
v_cndmask_b32 v233, v15, v14, vcc
s_mov_b32 vcc_lo, 0x10001
s_mov_b32 vcc_hi, 0x10001
v_cndmask_b32 v234, v15, v14, vcc
s_mov_b32 s60, 1069066811
s_mov_b32 s61, 1069066811
s_mov_b32 s62, 897988541
s_mov_b32 s55, 0
s_mov_b32 s56, 0
s_waitcnt lgkmcnt(0)
s_barrier
ds_read_b64_tr_b16 v[112:113], v12 offset:0
ds_read_b128 v[96:99], v10 offset:0
ds_read_b64_tr_b16 v[114:115], v12 offset:1280
ds_read_b128 v[100:103], v10 offset:2048
ds_read_b64_tr_b16 v[116:117], v13 offset:0
ds_read_b64_tr_b16 v[118:119], v13 offset:1280
ds_read_b64_tr_b16 v[120:121], v12 offset:64
ds_read_b64_tr_b16 v[122:123], v12 offset:1344
ds_read_b64_tr_b16 v[124:125], v13 offset:64
ds_read_b64_tr_b16 v[126:127], v13 offset:1344
ds_read_b64_tr_b16 v[128:129], v12 offset:128
ds_read_b64_tr_b16 v[130:131], v12 offset:1408
ds_read_b64_tr_b16 v[132:133], v13 offset:128
ds_read_b64_tr_b16 v[134:135], v13 offset:1408
v_mov_b32 v238, 0
s_mov_b64 exec, 1
global_load_dwordx2 v[236:237], v238, s[38:39] offset:128 sc1
s_mov_b64 exec, -1
s_lshl_b32 s50, s49, 4
s_add_u32 s50, s50, s46
s_lshl_b32 s50, s50, 7
s_add_u32 s50, s50, 3211264
s_lshl_b32 s51, s46, 2
s_add_u32 s51, s51, s49
s_lshl_b32 s51, s51, 7
s_add_u32 s51, s51, 3227648
s_cmp_eq_u32 s63, 1
s_cselect_b32 s50, s51, s50
s_cmp_lg_u32 s3, 0
s_cbranch_scc1 LG1_nt
v_lshlrev_b32 v240, 4, v1
v_add_u32 v240, s50, v240
v_mov_b32 v244, 0
v_mov_b32 v245, 0
v_mov_b32 v246, 0
v_mov_b32 v247, 0
s_mov_b64 exec, 0xff
global_store_dwordx4 v240, v[244:247], s[40:41] sc1
s_mov_b64 exec, -1
LG1_nt:
s_cmp_eq_u32 s63, 1
s_cbranch_scc1 LG1_qloop
.p2align 3
LG1_kvloop:
s_waitcnt lgkmcnt(10)
v_mfma_f32_16x16x32_bf16 v[16:19], v[96:99], v[112:115], v[16:19]
ds_read_b64_tr_b16 v[136:137], v8 offset:192
s_add_u32 s56, s56, 40960
v_mfma_f32_16x16x32_bf16 v[20:23], v[100:103], v[112:115], v[20:23]
ds_read_b64_tr_b16 v[138:139], v8 offset:1472
s_waitcnt lgkmcnt(10)
v_mfma_f32_16x16x32_bf16 v[24:27], v[96:99], v[116:119], v[24:27]
ds_read_b64_tr_b16 v[140:141], v9 offset:192
s_cmp_eq_u32 s56, 163840
v_mfma_f32_16x16x32_bf16 v[28:31], v[100:103], v[116:119], v[28:31]
ds_read_b64_tr_b16 v[142:143], v9 offset:1472
s_waitcnt lgkmcnt(10)
v_mfma_f32_16x16x32_bf16 v[32:35], v[96:99], v[120:123], v[32:35]
ds_read_b64_tr_b16 v[144:145], v8 offset:256
s_cselect_b32 s56, 0, s56
v_mfma_f32_16x16x32_bf16 v[36:39], v[100:103], v[120:123], v[36:39]
ds_read_b64_tr_b16 v[146:147], v8 offset:1536
s_waitcnt lgkmcnt(10)
v_mfma_f32_16x16x32_bf16 v[40:43], v[96:99], v[124:127], v[40:43]
ds_read_b64_tr_b16 v[148:149], v9 offset:256
s_add_u32 s55, s55, 1
v_mfma_f32_16x16x32_bf16 v[44:47], v[100:103], v[124:127], v[44:47]
ds_read_b64_tr_b16 v[150:151], v9 offset:1536
s_waitcnt lgkmcnt(10)
v_mfma_f32_16x16x32_bf16 v[48:51], v[96:99], v[128:131], v[48:51]
ds_read_b64_tr_b16 v[112:113], v8 offset:10240
ds_read_b128 v[104:107], v11 offset:0
v_mfma_f32_16x16x32_bf16 v[52:55], v[100:103], v[128:131], v[52:55]
ds_read_b64_tr_b16 v[114:115], v8 offset:11520
ds_read_b128 v[108:111], v11 offset:2048
s_waitcnt lgkmcnt(12)
v_mfma_f32_16x16x32_bf16 v[56:59], v[96:99], v[132:135], v[56:59]
ds_read_b64_tr_b16 v[116:117], v9 offset:10240
v_mfma_f32_16x16x32_bf16 v[60:63], v[100:103], v[132:135], v[60:63]
ds_read_b64_tr_b16 v[118:119], v9 offset:11520
s_waitcnt lgkmcnt(12)
v_mfma_f32_16x16x32_bf16 v[64:67], v[96:99], v[136:139], v[64:67]
ds_read_b64_tr_b16 v[120:121], v8 offset:10304
v_add_u32 v12, s56, v4
v_mfma_f32_16x16x32_bf16 v[68:71], v[100:103], v[136:139], v[68:71]
ds_read_b64_tr_b16 v[122:123], v8 offset:11584
s_waitcnt lgkmcnt(12)
v_mfma_f32_16x16x32_bf16 v[72:75], v[96:99], v[140:143], v[72:75]
ds_read_b64_tr_b16 v[124:125], v9 offset:10304
v_add_u32 v13, s56, v5
v_mfma_f32_16x16x32_bf16 v[76:79], v[100:103], v[140:143], v[76:79]
ds_read_b64_tr_b16 v[126:127], v9 offset:11584
s_waitcnt lgkmcnt(12)
v_mfma_f32_16x16x32_bf16 v[80:83], v[96:99], v[144:147], v[80:83]
ds_read_b64_tr_b16 v[128:129], v8 offset:10368
v_add_u32 v10, s56, v6
v_mfma_f32_16x16x32_bf16 v[84:87], v[100:103], v[144:147], v[84:87]
ds_read_b64_tr_b16 v[130:131], v8 offset:11648
s_waitcnt lgkmcnt(12)
v_mfma_f32_16x16x32_bf16 v[88:91], v[96:99], v[148:151], v[88:91]
ds_read_b64_tr_b16 v[132:133], v9 offset:10368
v_add_u32 v11, s56, v7
v_mfma_f32_16x16x32_bf16 v[92:95], v[100:103], v[148:151], v[92:95]
ds_read_b64_tr_b16 v[134:135], v9 offset:11648
s_waitcnt lgkmcnt(10)
v_mfma_f32_16x16x32_bf16 v[16:19], v[104:107], v[112:115], v[16:19]
ds_read_b64_tr_b16 v[136:137], v8 offset:10432
v_mfma_f32_16x16x32_bf16 v[20:23], v[108:111], v[112:115], v[20:23]
ds_read_b64_tr_b16 v[138:139], v8 offset:11712
s_waitcnt lgkmcnt(10)
v_mfma_f32_16x16x32_bf16 v[24:27], v[104:107], v[116:119], v[24:27]
ds_read_b64_tr_b16 v[140:141], v9 offset:10432
v_mfma_f32_16x16x32_bf16 v[28:31], v[108:111], v[116:119], v[28:31]
ds_read_b64_tr_b16 v[142:143], v9 offset:11712
s_waitcnt lgkmcnt(10)
v_mfma_f32_16x16x32_bf16 v[32:35], v[104:107], v[120:123], v[32:35]
ds_read_b64_tr_b16 v[144:145], v8 offset:10496
v_mfma_f32_16x16x32_bf16 v[36:39], v[108:111], v[120:123], v[36:39]
ds_read_b64_tr_b16 v[146:147], v8 offset:11776
s_waitcnt lgkmcnt(10)
v_mfma_f32_16x16x32_bf16 v[40:43], v[104:107], v[124:127], v[40:43]
ds_read_b64_tr_b16 v[148:149], v9 offset:10496
v_mfma_f32_16x16x32_bf16 v[44:47], v[108:111], v[124:127], v[44:47]
ds_read_b64_tr_b16 v[150:151], v9 offset:11776
s_waitcnt lgkmcnt(10)
v_mfma_f32_16x16x32_bf16 v[48:51], v[104:107], v[128:131], v[48:51]
s_barrier
ds_read_b64_tr_b16 v[112:113], v12 offset:0
ds_read_b128 v[96:99], v10 offset:0
v_mfma_f32_16x16x32_bf16 v[52:55], v[108:111], v[128:131], v[52:55]
ds_read_b64_tr_b16 v[114:115], v12 offset:1280
ds_read_b128 v[100:103], v10 offset:2048
s_waitcnt lgkmcnt(12)
v_mfma_f32_16x16x32_bf16 v[56:59], v[104:107], v[132:135], v[56:59]
ds_read_b64_tr_b16 v[116:117], v13 offset:0
v_mfma_f32_16x16x32_bf16 v[60:63], v[108:111], v[132:135], v[60:63]
ds_read_b64_tr_b16 v[118:119], v13 offset:1280
s_waitcnt lgkmcnt(12)
v_mfma_f32_16x16x32_bf16 v[64:67], v[104:107], v[136:139], v[64:67]
ds_read_b64_tr_b16 v[120:121], v12 offset:64
v_mov_b32 v8, v12
v_mfma_f32_16x16x32_bf16 v[68:71], v[108:111], v[136:139], v[68:71]
ds_read_b64_tr_b16 v[122:123], v12 offset:1344
s_waitcnt lgkmcnt(12)
v_mfma_f32_16x16x32_bf16 v[72:75], v[104:107], v[140:143], v[72:75]
ds_read_b64_tr_b16 v[124:125], v13 offset:64
v_mov_b32 v9, v13
v_mfma_f32_16x16x32_bf16 v[76:79], v[108:111], v[140:143], v[76:79]
ds_read_b64_tr_b16 v[126:127], v13 offset:1344
s_waitcnt lgkmcnt(12)
v_mfma_f32_16x16x32_bf16 v[80:83], v[104:107], v[144:147], v[80:83]
ds_read_b64_tr_b16 v[128:129], v12 offset:128
s_cmp_lt_u32 s55, 10
v_mfma_f32_16x16x32_bf16 v[84:87], v[108:111], v[144:147], v[84:87]
ds_read_b64_tr_b16 v[130:131], v12 offset:1408
s_waitcnt lgkmcnt(12)
v_mfma_f32_16x16x32_bf16 v[88:91], v[104:107], v[148:151], v[88:91]
ds_read_b64_tr_b16 v[132:133], v13 offset:128
v_mfma_f32_16x16x32_bf16 v[92:95], v[108:111], v[148:151], v[92:95]
ds_read_b64_tr_b16 v[134:135], v13 offset:1408
s_cbranch_scc1 LG1_kvloop
s_waitcnt lgkmcnt(0)
s_waitcnt vmcnt(0)
s_mov_b32 s67, 0
Lpl4:
v_readfirstlane_b32 s68, v236
v_readfirstlane_b32 s69, v237
s_add_u32 s67, s67, 1
s_cmp_lg_u32 s68, 0
s_cbranch_scc1 Lpe4
s_sleep 8
v_mov_b32 v238, 0
s_mov_b64 exec, 1
global_load_dwordx2 v[236:237], v238, s[38:39] offset:128 sc1
s_mov_b64 exec, -1
s_waitcnt vmcnt(0)
s_cmp_lt_u32 s67, 0x40000
s_cbranch_scc1 Lpl4
Lpe4:
.p2align 3
v_pk_mul_f32 v[212:213], v[16:17], s[60:61]
v_pk_mul_f32 v[214:215], v[18:19], s[60:61]
v_max_f32_e64 v16, s62, v16
v_exp_f32 v212, v212 clamp
v_exp_f32 v213, v213 clamp
v_exp_f32 v214, v214 clamp
v_exp_f32 v215, v215 clamp
v_max_f32_e64 v17, s62, v17
v_max_f32_e64 v18, s62, v18
v_max_f32_e64 v19, s62, v19
v_pk_add_f32 v[16:17], v[16:17], v[212:213]
v_pk_add_f32 v[18:19], v[18:19], v[214:215]
v_cvt_pk_bf16_f32 v96, v16, v17
v_cvt_pk_bf16_f32 v97, v18, v19
v_pk_mul_f32 v[212:213], v[20:21], s[60:61]
v_pk_mul_f32 v[214:215], v[22:23], s[60:61]
v_max_f32_e64 v20, s62, v20
v_exp_f32 v212, v212 clamp
v_exp_f32 v213, v213 clamp
v_exp_f32 v214, v214 clamp
v_exp_f32 v215, v215 clamp
v_max_f32_e64 v21, s62, v21
v_max_f32_e64 v22, s62, v22
v_max_f32_e64 v23, s62, v23
v_pk_add_f32 v[20:21], v[20:21], v[212:213]
v_pk_add_f32 v[22:23], v[22:23], v[214:215]
v_cvt_pk_bf16_f32 v98, v20, v21
v_cvt_pk_bf16_f32 v99, v22, v23
v_cvt_pk_bf16_f32 v116, v56, v57
v_cvt_pk_bf16_f32 v117, v58, v59
v_cvt_pk_bf16_f32 v118, v60, v61
v_cvt_pk_bf16_f32 v119, v62, v63
v_cvt_pk_bf16_f32 v120, v64, v65
v_cvt_pk_bf16_f32 v121, v66, v67
v_cvt_pk_bf16_f32 v122, v68, v69
v_cvt_pk_bf16_f32 v123, v70, v71
v_mfma_f32_16x16x32_bf16 v[192:195], v[96:99], v[216:219], 0
v_mfma_f32_16x16x32_bf16 v[140:143], v[96:99], v[116:119], 0
v_mfma_f32_16x16x32_bf16 v[144:147], v[96:99], v[120:123], 0
v_pk_mul_f32 v[212:213], v[24:25], s[60:61]
v_pk_mul_f32 v[214:215], v[26:27], s[60:61]
v_max_f32_e64 v24, s62, v24
v_exp_f32 v212, v212 clamp
v_exp_f32 v213, v213 clamp
v_exp_f32 v214, v214 clamp
v_exp_f32 v215, v215 clamp
v_max_f32_e64 v25, s62, v25
v_max_f32_e64 v26, s62, v26
v_max_f32_e64 v27, s62, v27
v_pk_add_f32 v[24:25], v[24:25], v[212:213]
v_pk_add_f32 v[26:27], v[26:27], v[214:215]
v_cvt_pk_bf16_f32 v100, v24, v25
v_cvt_pk_bf16_f32 v101, v26, v27
v_pk_mul_f32 v[212:213], v[28:29], s[60:61]
v_pk_mul_f32 v[214:215], v[30:31], s[60:61]
v_max_f32_e64 v28, s62, v28
v_exp_f32 v212, v212 clamp
v_exp_f32 v213, v213 clamp
v_exp_f32 v214, v214 clamp
v_exp_f32 v215, v215 clamp
v_max_f32_e64 v29, s62, v29
v_max_f32_e64 v30, s62, v30
v_max_f32_e64 v31, s62, v31
v_pk_add_f32 v[28:29], v[28:29], v[212:213]
v_pk_add_f32 v[30:31], v[30:31], v[214:215]
v_cvt_pk_bf16_f32 v102, v28, v29
v_cvt_pk_bf16_f32 v103, v30, v31
v_cvt_pk_bf16_f32 v124, v72, v73
v_cvt_pk_bf16_f32 v125, v74, v75
v_cvt_pk_bf16_f32 v126, v76, v77
v_cvt_pk_bf16_f32 v127, v78, v79
v_mfma_f32_16x16x32_bf16 v[196:199], v[100:103], v[216:219], 0
v_mfma_f32_16x16x32_bf16 v[148:151], v[100:103], v[116:119], 0
v_mfma_f32_16x16x32_bf16 v[152:155], v[100:103], v[120:123], 0
v_mfma_f32_16x16x32_bf16 v[156:159], v[100:103], v[124:127], 0
v_pk_mul_f32 v[212:213], v[32:33], s[60:61]
v_pk_mul_f32 v[214:215], v[34:35], s[60:61]
v_max_f32_e64 v32, s62, v32
v_exp_f32 v212, v212 clamp
v_exp_f32 v213, v213 clamp
v_exp_f32 v214, v214 clamp
v_exp_f32 v215, v215 clamp
v_max_f32_e64 v33, s62, v33
v_max_f32_e64 v34, s62, v34
v_max_f32_e64 v35, s62, v35
v_pk_add_f32 v[32:33], v[32:33], v[212:213]
v_pk_add_f32 v[34:35], v[34:35], v[214:215]
v_cvt_pk_bf16_f32 v104, v32, v33
v_cvt_pk_bf16_f32 v105, v34, v35
v_pk_mul_f32 v[212:213], v[36:37], s[60:61]
v_pk_mul_f32 v[214:215], v[38:39], s[60:61]
v_max_f32_e64 v36, s62, v36
v_exp_f32 v212, v212 clamp
v_exp_f32 v213, v213 clamp
v_exp_f32 v214, v214 clamp
v_exp_f32 v215, v215 clamp
v_max_f32_e64 v37, s62, v37
v_max_f32_e64 v38, s62, v38
v_max_f32_e64 v39, s62, v39
v_pk_add_f32 v[36:37], v[36:37], v[212:213]
v_pk_add_f32 v[38:39], v[38:39], v[214:215]
v_cvt_pk_bf16_f32 v106, v36, v37
v_cvt_pk_bf16_f32 v107, v38, v39
v_cvt_pk_bf16_f32 v128, v80, v81
v_cvt_pk_bf16_f32 v129, v82, v83
v_cvt_pk_bf16_f32 v130, v84, v85
v_cvt_pk_bf16_f32 v131, v86, v87
v_mfma_f32_16x16x32_bf16 v[200:203], v[104:107], v[216:219], 0
v_mfma_f32_16x16x32_bf16 v[160:163], v[104:107], v[120:123], 0
v_mfma_f32_16x16x32_bf16 v[164:167], v[104:107], v[124:127], 0
v_mfma_f32_16x16x32_bf16 v[168:171], v[104:107], v[128:131], 0
v_pk_mul_f32 v[212:213], v[40:41], s[60:61]
v_pk_mul_f32 v[214:215], v[42:43], s[60:61]
v_max_f32_e64 v40, s62, v40
v_exp_f32 v212, v212 clamp
v_exp_f32 v213, v213 clamp
v_exp_f32 v214, v214 clamp
v_exp_f32 v215, v215 clamp
v_max_f32_e64 v41, s62, v41
v_max_f32_e64 v42, s62, v42
v_max_f32_e64 v43, s62, v43
v_pk_add_f32 v[40:41], v[40:41], v[212:213]
v_pk_add_f32 v[42:43], v[42:43], v[214:215]
v_cvt_pk_bf16_f32 v108, v40, v41
v_cvt_pk_bf16_f32 v109, v42, v43
v_pk_mul_f32 v[212:213], v[44:45], s[60:61]
v_pk_mul_f32 v[214:215], v[46:47], s[60:61]
v_max_f32_e64 v44, s62, v44
v_exp_f32 v212, v212 clamp
v_exp_f32 v213, v213 clamp
v_exp_f32 v214, v214 clamp
v_exp_f32 v215, v215 clamp
v_max_f32_e64 v45, s62, v45
v_max_f32_e64 v46, s62, v46
v_max_f32_e64 v47, s62, v47
v_pk_add_f32 v[44:45], v[44:45], v[212:213]
v_pk_add_f32 v[46:47], v[46:47], v[214:215]
v_cvt_pk_bf16_f32 v110, v44, v45
v_cvt_pk_bf16_f32 v111, v46, v47
v_cvt_pk_bf16_f32 v132, v88, v89
v_cvt_pk_bf16_f32 v133, v90, v91
v_cvt_pk_bf16_f32 v134, v92, v93
v_cvt_pk_bf16_f32 v135, v94, v95
v_mfma_f32_16x16x32_bf16 v[204:207], v[108:111], v[216:219], 0
v_mfma_f32_16x16x32_bf16 v[172:175], v[108:111], v[124:127], 0
v_mfma_f32_16x16x32_bf16 v[176:179], v[108:111], v[128:131], 0
v_mfma_f32_16x16x32_bf16 v[180:183], v[108:111], v[132:135], 0
v_pk_mul_f32 v[212:213], v[48:49], s[60:61]
v_pk_mul_f32 v[214:215], v[50:51], s[60:61]
v_max_f32_e64 v48, s62, v48
v_exp_f32 v212, v212 clamp
v_exp_f32 v213, v213 clamp
v_exp_f32 v214, v214 clamp
v_exp_f32 v215, v215 clamp
v_max_f32_e64 v49, s62, v49
v_max_f32_e64 v50, s62, v50
v_max_f32_e64 v51, s62, v51
v_pk_add_f32 v[48:49], v[48:49], v[212:213]
v_pk_add_f32 v[50:51], v[50:51], v[214:215]
v_cvt_pk_bf16_f32 v112, v48, v49
v_cvt_pk_bf16_f32 v113, v50, v51
v_pk_mul_f32 v[212:213], v[52:53], s[60:61]
v_pk_mul_f32 v[214:215], v[54:55], s[60:61]
v_max_f32_e64 v52, s62, v52
v_exp_f32 v212, v212 clamp
v_exp_f32 v213, v213 clamp
v_exp_f32 v214, v214 clamp
v_exp_f32 v215, v215 clamp
v_max_f32_e64 v53, s62, v53
v_max_f32_e64 v54, s62, v54
v_max_f32_e64 v55, s62, v55
v_pk_add_f32 v[52:53], v[52:53], v[212:213]
v_pk_add_f32 v[54:55], v[54:55], v[214:215]
v_cvt_pk_bf16_f32 v114, v52, v53
v_cvt_pk_bf16_f32 v115, v54, v55
s_nop 1
v_mfma_f32_16x16x32_bf16 v[208:211], v[112:115], v[216:219], 0
v_mfma_f32_16x16x32_bf16 v[184:187], v[112:115], v[128:131], 0
v_mfma_f32_16x16x32_bf16 v[188:191], v[112:115], v[132:135], 0
ds_write_b128 v220, v[140:143] offset:0
v_cndmask_b32 v144, v144, v192, s[4:5]
v_cndmask_b32 v145, v145, v193, s[4:5]
v_cndmask_b32 v146, v146, v194, s[4:5]
v_cndmask_b32 v147, v147, v195, s[4:5]
ds_write_b128 v221, v[144:147] offset:1280
ds_write_b128 v222, v[148:151] offset:64
v_cndmask_b32 v152, v152, v196, s[6:7]
v_cndmask_b32 v153, v153, v197, s[6:7]
v_cndmask_b32 v154, v154, v198, s[6:7]
v_cndmask_b32 v155, v155, v199, s[6:7]
ds_write_b128 v223, v[152:155] offset:1344
v_cndmask_b32 v156, v156, v196, s[8:9]
v_cndmask_b32 v157, v157, v197, s[8:9]
v_cndmask_b32 v158, v158, v198, s[8:9]
v_cndmask_b32 v159, v159, v199, s[8:9]
ds_write_b128 v224, v[156:159] offset:2624
ds_write_b128 v225, v[160:163] offset:1408
v_cndmask_b32 v164, v164, v200, s[10:11]
v_cndmask_b32 v165, v165, v201, s[10:11]
v_cndmask_b32 v166, v166, v202, s[10:11]
v_cndmask_b32 v167, v167, v203, s[10:11]
ds_write_b128 v226, v[164:167] offset:2688
v_cndmask_b32 v168, v168, v200, s[12:13]
v_cndmask_b32 v169, v169, v201, s[12:13]
v_cndmask_b32 v170, v170, v202, s[12:13]
v_cndmask_b32 v171, v171, v203, s[12:13]
ds_write_b128 v227, v[168:171] offset:3968
ds_write_b128 v228, v[172:175] offset:2752
v_cndmask_b32 v176, v176, v204, s[14:15]
v_cndmask_b32 v177, v177, v205, s[14:15]
v_cndmask_b32 v178, v178, v206, s[14:15]
v_cndmask_b32 v179, v179, v207, s[14:15]
ds_write_b128 v229, v[176:179] offset:4032
ds_write_b128 v230, v[180:183] offset:5312
ds_write_b128 v231, v[204:207] offset:6592
ds_write_b128 v232, v[184:187] offset:4096
ds_write_b128 v233, v[188:191] offset:5376
ds_write_b128 v234, v[208:211] offset:6656
s_branch LG1_red
.p2align 3
LG1_qloop:
s_waitcnt lgkmcnt(10)
v_mfma_f32_16x16x32_bf16 v[16:19], v[112:115], v[96:99], v[16:19]
ds_read_b64_tr_b16 v[136:137], v8 offset:192
s_add_u32 s56, s56, 40960
v_mfma_f32_16x16x32_bf16 v[20:23], v[112:115], v[100:103], v[20:23]
ds_read_b64_tr_b16 v[138:139], v8 offset:1472
s_waitcnt lgkmcnt(10)
v_mfma_f32_16x16x32_bf16 v[24:27], v[116:119], v[96:99], v[24:27]
ds_read_b64_tr_b16 v[140:141], v9 offset:192
s_cmp_eq_u32 s56, 163840
v_mfma_f32_16x16x32_bf16 v[28:31], v[116:119], v[100:103], v[28:31]
ds_read_b64_tr_b16 v[142:143], v9 offset:1472
s_waitcnt lgkmcnt(10)
v_mfma_f32_16x16x32_bf16 v[32:35], v[120:123], v[96:99], v[32:35]
ds_read_b64_tr_b16 v[144:145], v8 offset:256
s_cselect_b32 s56, 0, s56
v_mfma_f32_16x16x32_bf16 v[36:39], v[120:123], v[100:103], v[36:39]
ds_read_b64_tr_b16 v[146:147], v8 offset:1536
s_waitcnt lgkmcnt(10)
v_mfma_f32_16x16x32_bf16 v[40:43], v[124:127], v[96:99], v[40:43]
ds_read_b64_tr_b16 v[148:149], v9 offset:256
s_add_u32 s55, s55, 1
v_mfma_f32_16x16x32_bf16 v[44:47], v[124:127], v[100:103], v[44:47]
ds_read_b64_tr_b16 v[150:151], v9 offset:1536
s_waitcnt lgkmcnt(10)
v_mfma_f32_16x16x32_bf16 v[48:51], v[128:131], v[96:99], v[48:51]
ds_read_b64_tr_b16 v[112:113], v8 offset:10240
ds_read_b128 v[104:107], v11 offset:0
v_mfma_f32_16x16x32_bf16 v[52:55], v[128:131], v[100:103], v[52:55]
ds_read_b64_tr_b16 v[114:115], v8 offset:11520
ds_read_b128 v[108:111], v11 offset:2048
s_waitcnt lgkmcnt(12)
v_mfma_f32_16x16x32_bf16 v[56:59], v[132:135], v[96:99], v[56:59]
ds_read_b64_tr_b16 v[116:117], v9 offset:10240
v_mfma_f32_16x16x32_bf16 v[60:63], v[132:135], v[100:103], v[60:63]
ds_read_b64_tr_b16 v[118:119], v9 offset:11520
s_waitcnt lgkmcnt(12)
v_mfma_f32_16x16x32_bf16 v[64:67], v[136:139], v[96:99], v[64:67]
ds_read_b64_tr_b16 v[120:121], v8 offset:10304
v_add_u32 v12, s56, v4
v_mfma_f32_16x16x32_bf16 v[68:71], v[136:139], v[100:103], v[68:71]
ds_read_b64_tr_b16 v[122:123], v8 offset:11584
s_waitcnt lgkmcnt(12)
v_mfma_f32_16x16x32_bf16 v[72:75], v[140:143], v[96:99], v[72:75]
ds_read_b64_tr_b16 v[124:125], v9 offset:10304
v_add_u32 v13, s56, v5
v_mfma_f32_16x16x32_bf16 v[76:79], v[140:143], v[100:103], v[76:79]
ds_read_b64_tr_b16 v[126:127], v9 offset:11584
s_waitcnt lgkmcnt(12)
v_mfma_f32_16x16x32_bf16 v[80:83], v[144:147], v[96:99], v[80:83]
ds_read_b64_tr_b16 v[128:129], v8 offset:10368
v_add_u32 v10, s56, v6
v_mfma_f32_16x16x32_bf16 v[84:87], v[144:147], v[100:103], v[84:87]
ds_read_b64_tr_b16 v[130:131], v8 offset:11648
s_waitcnt lgkmcnt(12)
v_mfma_f32_16x16x32_bf16 v[88:91], v[148:151], v[96:99], v[88:91]
ds_read_b64_tr_b16 v[132:133], v9 offset:10368
v_add_u32 v11, s56, v7
v_mfma_f32_16x16x32_bf16 v[92:95], v[148:151], v[100:103], v[92:95]
ds_read_b64_tr_b16 v[134:135], v9 offset:11648
s_waitcnt lgkmcnt(10)
v_mfma_f32_16x16x32_bf16 v[16:19], v[112:115], v[104:107], v[16:19]
ds_read_b64_tr_b16 v[136:137], v8 offset:10432
v_mfma_f32_16x16x32_bf16 v[20:23], v[112:115], v[108:111], v[20:23]
ds_read_b64_tr_b16 v[138:139], v8 offset:11712
s_waitcnt lgkmcnt(10)
v_mfma_f32_16x16x32_bf16 v[24:27], v[116:119], v[104:107], v[24:27]
ds_read_b64_tr_b16 v[140:141], v9 offset:10432
v_mfma_f32_16x16x32_bf16 v[28:31], v[116:119], v[108:111], v[28:31]
ds_read_b64_tr_b16 v[142:143], v9 offset:11712
s_waitcnt lgkmcnt(10)
v_mfma_f32_16x16x32_bf16 v[32:35], v[120:123], v[104:107], v[32:35]
ds_read_b64_tr_b16 v[144:145], v8 offset:10496
v_mfma_f32_16x16x32_bf16 v[36:39], v[120:123], v[108:111], v[36:39]
ds_read_b64_tr_b16 v[146:147], v8 offset:11776
s_waitcnt lgkmcnt(10)
v_mfma_f32_16x16x32_bf16 v[40:43], v[124:127], v[104:107], v[40:43]
ds_read_b64_tr_b16 v[148:149], v9 offset:10496
v_mfma_f32_16x16x32_bf16 v[44:47], v[124:127], v[108:111], v[44:47]
ds_read_b64_tr_b16 v[150:151], v9 offset:11776
s_waitcnt lgkmcnt(10)
v_mfma_f32_16x16x32_bf16 v[48:51], v[128:131], v[104:107], v[48:51]
s_barrier
ds_read_b64_tr_b16 v[112:113], v12 offset:0
ds_read_b128 v[96:99], v10 offset:0
v_mfma_f32_16x16x32_bf16 v[52:55], v[128:131], v[108:111], v[52:55]
ds_read_b64_tr_b16 v[114:115], v12 offset:1280
ds_read_b128 v[100:103], v10 offset:2048
s_waitcnt lgkmcnt(12)
v_mfma_f32_16x16x32_bf16 v[56:59], v[132:135], v[104:107], v[56:59]
ds_read_b64_tr_b16 v[116:117], v13 offset:0
v_mfma_f32_16x16x32_bf16 v[60:63], v[132:135], v[108:111], v[60:63]
ds_read_b64_tr_b16 v[118:119], v13 offset:1280
s_waitcnt lgkmcnt(12)
v_mfma_f32_16x16x32_bf16 v[64:67], v[136:139], v[104:107], v[64:67]
ds_read_b64_tr_b16 v[120:121], v12 offset:64
v_mov_b32 v8, v12
v_mfma_f32_16x16x32_bf16 v[68:71], v[136:139], v[108:111], v[68:71]
ds_read_b64_tr_b16 v[122:123], v12 offset:1344
s_waitcnt lgkmcnt(12)
v_mfma_f32_16x16x32_bf16 v[72:75], v[140:143], v[104:107], v[72:75]
ds_read_b64_tr_b16 v[124:125], v13 offset:64
v_mov_b32 v9, v13
v_mfma_f32_16x16x32_bf16 v[76:79], v[140:143], v[108:111], v[76:79]
ds_read_b64_tr_b16 v[126:127], v13 offset:1344
s_waitcnt lgkmcnt(12)
v_mfma_f32_16x16x32_bf16 v[80:83], v[144:147], v[104:107], v[80:83]
ds_read_b64_tr_b16 v[128:129], v12 offset:128
s_cmp_lt_u32 s55, 10
v_mfma_f32_16x16x32_bf16 v[84:87], v[144:147], v[108:111], v[84:87]
ds_read_b64_tr_b16 v[130:131], v12 offset:1408
s_waitcnt lgkmcnt(12)
v_mfma_f32_16x16x32_bf16 v[88:91], v[148:151], v[104:107], v[88:91]
ds_read_b64_tr_b16 v[132:133], v13 offset:128
v_mfma_f32_16x16x32_bf16 v[92:95], v[148:151], v[108:111], v[92:95]
ds_read_b64_tr_b16 v[134:135], v13 offset:1408
s_cbranch_scc1 LG1_qloop
s_waitcnt lgkmcnt(0)
s_waitcnt vmcnt(0)
s_mov_b32 s67, 0
Lpl5:
v_readfirstlane_b32 s68, v236
v_readfirstlane_b32 s69, v237
s_add_u32 s67, s67, 1
s_cmp_lg_u32 s68, 0
s_cbranch_scc1 Lpe5
s_sleep 8
v_mov_b32 v238, 0
s_mov_b64 exec, 1
global_load_dwordx2 v[236:237], v238, s[38:39] offset:128 sc1
s_mov_b64 exec, -1
s_waitcnt vmcnt(0)
s_cmp_lt_u32 s67, 0x40000
s_cbranch_scc1 Lpl5
Lpe5:
s_add_u32 s8, s40, 0
s_addc_u32 s9, s41, 0
s_mov_b32 s10, 2621440
s_mov_b32 s11, 0x20000
v_lshlrev_b32 v5, 4, v1
s_mul_i32 s55, s49, 10240
s_add_u32 s55, s55, s53
.p2align 3
v_pk_mul_f32 v[176:177], v[16:17], s[60:61]
v_pk_mul_f32 v[178:179], v[18:19], s[60:61]
v_max_f32_e64 v16, s62, v16
v_exp_f32 v176, v176 clamp
v_exp_f32 v177, v177 clamp
v_exp_f32 v178, v178 clamp
v_exp_f32 v179, v179 clamp
v_max_f32_e64 v17, s62, v17
v_max_f32_e64 v18, s62, v18
v_max_f32_e64 v19, s62, v19
v_pk_add_f32 v[16:17], v[16:17], v[176:177]
v_pk_add_f32 v[18:19], v[18:19], v[178:179]
v_cvt_pk_bf16_f32 v96, v16, v17
v_cvt_pk_bf16_f32 v97, v18, v19
v_pk_mul_f32 v[176:177], v[20:21], s[60:61]
v_pk_mul_f32 v[178:179], v[22:23], s[60:61]
v_max_f32_e64 v20, s62, v20
v_exp_f32 v176, v176 clamp
v_exp_f32 v177, v177 clamp
v_exp_f32 v178, v178 clamp
v_exp_f32 v179, v179 clamp
v_max_f32_e64 v21, s62, v21
v_max_f32_e64 v22, s62, v22
v_max_f32_e64 v23, s62, v23
v_pk_add_f32 v[20:21], v[20:21], v[176:177]
v_pk_add_f32 v[22:23], v[22:23], v[178:179]
v_cvt_pk_bf16_f32 v98, v20, v21
v_cvt_pk_bf16_f32 v99, v22, v23
v_pk_mul_f32 v[176:177], v[24:25], s[60:61]
v_pk_mul_f32 v[178:179], v[26:27], s[60:61]
v_max_f32_e64 v24, s62, v24
v_exp_f32 v176, v176 clamp
v_exp_f32 v177, v177 clamp
v_exp_f32 v178, v178 clamp
v_exp_f32 v179, v179 clamp
v_max_f32_e64 v25, s62, v25
v_max_f32_e64 v26, s62, v26
v_max_f32_e64 v27, s62, v27
v_permlane16_swap_b32 v96, v98
v_permlane16_swap_b32 v97, v99
buffer_store_dwordx4 v[96:99], v5, s[8:11], s55 offen offset:0 sc1
v_pk_add_f32 v[24:25], v[24:25], v[176:177]
v_pk_add_f32 v[26:27], v[26:27], v[178:179]
v_cvt_pk_bf16_f32 v100, v24, v25
v_cvt_pk_bf16_f32 v101, v26, v27
v_pk_mul_f32 v[176:177], v[28:29], s[60:61]
v_pk_mul_f32 v[178:179], v[30:31], s[60:61]
v_max_f32_e64 v28, s62, v28
v_exp_f32 v176, v176 clamp
v_exp_f32 v177, v177 clamp
v_exp_f32 v178, v178 clamp
v_exp_f32 v179, v179 clamp
v_max_f32_e64 v29, s62, v29
v_max_f32_e64 v30, s62, v30
v_max_f32_e64 v31, s62, v31
v_pk_add_f32 v[28:29], v[28:29], v[176:177]
v_pk_add_f32 v[30:31], v[30:31], v[178:179]
v_cvt_pk_bf16_f32 v102, v28, v29
v_cvt_pk_bf16_f32 v103, v30, v31
v_pk_mul_f32 v[176:177], v[32:33], s[60:61]
v_pk_mul_f32 v[178:179], v[34:35], s[60:61]
v_max_f32_e64 v32, s62, v32
v_exp_f32 v176, v176 clamp
v_exp_f32 v177, v177 clamp
v_exp_f32 v178, v178 clamp
v_exp_f32 v179, v179 clamp
v_max_f32_e64 v33, s62, v33
v_max_f32_e64 v34, s62, v34
v_max_f32_e64 v35, s62, v35
v_permlane16_swap_b32 v100, v102
v_permlane16_swap_b32 v101, v103
buffer_store_dwordx4 v[100:103], v5, s[8:11], s55 offen offset:1024 sc1
v_pk_add_f32 v[32:33], v[32:33], v[176:177]
v_pk_add_f32 v[34:35], v[34:35], v[178:179]
v_cvt_pk_bf16_f32 v104, v32, v33
v_cvt_pk_bf16_f32 v105, v34, v35
v_pk_mul_f32 v[176:177], v[36:37], s[60:61]
v_pk_mul_f32 v[178:179], v[38:39], s[60:61]
v_max_f32_e64 v36, s62, v36
v_exp_f32 v176, v176 clamp
v_exp_f32 v177, v177 clamp
v_exp_f32 v178, v178 clamp
v_exp_f32 v179, v179 clamp
v_max_f32_e64 v37, s62, v37
v_max_f32_e64 v38, s62, v38
v_max_f32_e64 v39, s62, v39
v_pk_add_f32 v[36:37], v[36:37], v[176:177]
v_pk_add_f32 v[38:39], v[38:39], v[178:179]
v_cvt_pk_bf16_f32 v106, v36, v37
v_cvt_pk_bf16_f32 v107, v38, v39
v_pk_mul_f32 v[176:177], v[40:41], s[60:61]
v_pk_mul_f32 v[178:179], v[42:43], s[60:61]
v_max_f32_e64 v40, s62, v40
v_exp_f32 v176, v176 clamp
v_exp_f32 v177, v177 clamp
v_exp_f32 v178, v178 clamp
v_exp_f32 v179, v179 clamp
v_max_f32_e64 v41, s62, v41
v_max_f32_e64 v42, s62, v42
v_max_f32_e64 v43, s62, v43
v_permlane16_swap_b32 v104, v106
v_permlane16_swap_b32 v105, v107
buffer_store_dwordx4 v[104:107], v5, s[8:11], s55 offen offset:2048 sc1
v_pk_add_f32 v[40:41], v[40:41], v[176:177]
v_pk_add_f32 v[42:43], v[42:43], v[178:179]
v_cvt_pk_bf16_f32 v108, v40, v41
v_cvt_pk_bf16_f32 v109, v42, v43
v_pk_mul_f32 v[176:177], v[44:45], s[60:61]
v_pk_mul_f32 v[178:179], v[46:47], s[60:61]
v_max_f32_e64 v44, s62, v44
v_exp_f32 v176, v176 clamp
v_exp_f32 v177, v177 clamp
v_exp_f32 v178, v178 clamp
v_exp_f32 v179, v179 clamp
v_max_f32_e64 v45, s62, v45
v_max_f32_e64 v46, s62, v46
v_max_f32_e64 v47, s62, v47
v_pk_add_f32 v[44:45], v[44:45], v[176:177]
v_pk_add_f32 v[46:47], v[46:47], v[178:179]
v_cvt_pk_bf16_f32 v110, v44, v45
v_cvt_pk_bf16_f32 v111, v46, v47
v_pk_mul_f32 v[176:177], v[48:49], s[60:61]
v_pk_mul_f32 v[178:179], v[50:51], s[60:61]
v_max_f32_e64 v48, s62, v48
v_exp_f32 v176, v176 clamp
v_exp_f32 v177, v177 clamp
v_exp_f32 v178, v178 clamp
v_exp_f32 v179, v179 clamp
v_max_f32_e64 v49, s62, v49
v_max_f32_e64 v50, s62, v50
v_max_f32_e64 v51, s62, v51
v_permlane16_swap_b32 v108, v110
v_permlane16_swap_b32 v109, v111
buffer_store_dwordx4 v[108:111], v5, s[8:11], s55 offen offset:3072 sc1
s_add_u32 s55, s55, 4096
v_pk_add_f32 v[48:49], v[48:49], v[176:177]
v_pk_add_f32 v[50:51], v[50:51], v[178:179]
v_cvt_pk_bf16_f32 v112, v48, v49
v_cvt_pk_bf16_f32 v113, v50, v51
v_pk_mul_f32 v[176:177], v[52:53], s[60:61]
v_pk_mul_f32 v[178:179], v[54:55], s[60:61]
v_max_f32_e64 v52, s62, v52
v_exp_f32 v176, v176 clamp
v_exp_f32 v177, v177 clamp
v_exp_f32 v178, v178 clamp
v_exp_f32 v179, v179 clamp
v_max_f32_e64 v53, s62, v53
v_max_f32_e64 v54, s62, v54
v_max_f32_e64 v55, s62, v55
v_pk_add_f32 v[52:53], v[52:53], v[176:177]
v_pk_add_f32 v[54:55], v[54:55], v[178:179]
v_cvt_pk_bf16_f32 v114, v52, v53
v_cvt_pk_bf16_f32 v115, v54, v55
v_pk_mul_f32 v[176:177], v[56:57], s[60:61]
v_pk_mul_f32 v[178:179], v[58:59], s[60:61]
v_max_f32_e64 v56, s62, v56
v_exp_f32 v176, v176 clamp
v_exp_f32 v177, v177 clamp
v_exp_f32 v178, v178 clamp
v_exp_f32 v179, v179 clamp
v_max_f32_e64 v57, s62, v57
v_max_f32_e64 v58, s62, v58
v_max_f32_e64 v59, s62, v59
v_permlane16_swap_b32 v112, v114
v_permlane16_swap_b32 v113, v115
buffer_store_dwordx4 v[112:115], v5, s[8:11], s55 offen offset:0 sc1
v_pk_add_f32 v[56:57], v[56:57], v[176:177]
v_pk_add_f32 v[58:59], v[58:59], v[178:179]
v_cvt_pk_bf16_f32 v116, v56, v57
v_cvt_pk_bf16_f32 v117, v58, v59
v_pk_mul_f32 v[176:177], v[60:61], s[60:61]
v_pk_mul_f32 v[178:179], v[62:63], s[60:61]
v_max_f32_e64 v60, s62, v60
v_exp_f32 v176, v176 clamp
v_exp_f32 v177, v177 clamp
v_exp_f32 v178, v178 clamp
v_exp_f32 v179, v179 clamp
v_max_f32_e64 v61, s62, v61
v_max_f32_e64 v62, s62, v62
v_max_f32_e64 v63, s62, v63
v_pk_add_f32 v[60:61], v[60:61], v[176:177]
v_pk_add_f32 v[62:63], v[62:63], v[178:179]
v_cvt_pk_bf16_f32 v118, v60, v61
v_cvt_pk_bf16_f32 v119, v62, v63
v_pk_mul_f32 v[176:177], v[64:65], s[60:61]
v_pk_mul_f32 v[178:179], v[66:67], s[60:61]
v_max_f32_e64 v64, s62, v64
v_exp_f32 v176, v176 clamp
v_exp_f32 v177, v177 clamp
v_exp_f32 v178, v178 clamp
v_exp_f32 v179, v179 clamp
v_max_f32_e64 v65, s62, v65
v_max_f32_e64 v66, s62, v66
v_max_f32_e64 v67, s62, v67
v_permlane16_swap_b32 v116, v118
v_permlane16_swap_b32 v117, v119
buffer_store_dwordx4 v[116:119], v5, s[8:11], s55 offen offset:1024 sc1
v_pk_add_f32 v[64:65], v[64:65], v[176:177]
v_pk_add_f32 v[66:67], v[66:67], v[178:179]
v_cvt_pk_bf16_f32 v120, v64, v65
v_cvt_pk_bf16_f32 v121, v66, v67
v_pk_mul_f32 v[176:177], v[68:69], s[60:61]
v_pk_mul_f32 v[178:179], v[70:71], s[60:61]
v_max_f32_e64 v68, s62, v68
v_exp_f32 v176, v176 clamp
v_exp_f32 v177, v177 clamp
v_exp_f32 v178, v178 clamp
v_exp_f32 v179, v179 clamp
v_max_f32_e64 v69, s62, v69
v_max_f32_e64 v70, s62, v70
v_max_f32_e64 v71, s62, v71
v_pk_add_f32 v[68:69], v[68:69], v[176:177]
v_pk_add_f32 v[70:71], v[70:71], v[178:179]
v_cvt_pk_bf16_f32 v122, v68, v69
v_cvt_pk_bf16_f32 v123, v70, v71
v_pk_mul_f32 v[176:177], v[72:73], s[60:61]
v_pk_mul_f32 v[178:179], v[74:75], s[60:61]
v_max_f32_e64 v72, s62, v72
v_exp_f32 v176, v176 clamp
v_exp_f32 v177, v177 clamp
v_exp_f32 v178, v178 clamp
v_exp_f32 v179, v179 clamp
v_max_f32_e64 v73, s62, v73
v_max_f32_e64 v74, s62, v74
v_max_f32_e64 v75, s62, v75
v_permlane16_swap_b32 v120, v122
v_permlane16_swap_b32 v121, v123
buffer_store_dwordx4 v[120:123], v5, s[8:11], s55 offen offset:2048 sc1
v_pk_add_f32 v[72:73], v[72:73], v[176:177]
v_pk_add_f32 v[74:75], v[74:75], v[178:179]
v_cvt_pk_bf16_f32 v124, v72, v73
v_cvt_pk_bf16_f32 v125, v74, v75
v_pk_mul_f32 v[176:177], v[76:77], s[60:61]
v_pk_mul_f32 v[178:179], v[78:79], s[60:61]
v_max_f32_e64 v76, s62, v76
v_exp_f32 v176, v176 clamp
v_exp_f32 v177, v177 clamp
v_exp_f32 v178, v178 clamp
v_exp_f32 v179, v179 clamp
v_max_f32_e64 v77, s62, v77
v_max_f32_e64 v78, s62, v78
v_max_f32_e64 v79, s62, v79
v_pk_add_f32 v[76:77], v[76:77], v[176:177]
v_pk_add_f32 v[78:79], v[78:79], v[178:179]
v_cvt_pk_bf16_f32 v126, v76, v77
v_cvt_pk_bf16_f32 v127, v78, v79
v_pk_mul_f32 v[176:177], v[80:81], s[60:61]
v_pk_mul_f32 v[178:179], v[82:83], s[60:61]
v_max_f32_e64 v80, s62, v80
v_exp_f32 v176, v176 clamp
v_exp_f32 v177, v177 clamp
v_exp_f32 v178, v178 clamp
v_exp_f32 v179, v179 clamp
v_max_f32_e64 v81, s62, v81
v_max_f32_e64 v82, s62, v82
v_max_f32_e64 v83, s62, v83
v_permlane16_swap_b32 v124, v126
v_permlane16_swap_b32 v125, v127
buffer_store_dwordx4 v[124:127], v5, s[8:11], s55 offen offset:3072 sc1
s_add_u32 s55, s55, 4096
v_pk_add_f32 v[80:81], v[80:81], v[176:177]
v_pk_add_f32 v[82:83], v[82:83], v[178:179]
v_cvt_pk_bf16_f32 v128, v80, v81
v_cvt_pk_bf16_f32 v129, v82, v83
v_pk_mul_f32 v[176:177], v[84:85], s[60:61]
v_pk_mul_f32 v[178:179], v[86:87], s[60:61]
v_max_f32_e64 v84, s62, v84
v_exp_f32 v176, v176 clamp
v_exp_f32 v177, v177 clamp
v_exp_f32 v178, v178 clamp
v_exp_f32 v179, v179 clamp
v_max_f32_e64 v85, s62, v85
v_max_f32_e64 v86, s62, v86
v_max_f32_e64 v87, s62, v87
v_pk_add_f32 v[84:85], v[84:85], v[176:177]
v_pk_add_f32 v[86:87], v[86:87], v[178:179]
v_cvt_pk_bf16_f32 v130, v84, v85
v_cvt_pk_bf16_f32 v131, v86, v87
v_pk_mul_f32 v[176:177], v[88:89], s[60:61]
v_pk_mul_f32 v[178:179], v[90:91], s[60:61]
v_max_f32_e64 v88, s62, v88
v_exp_f32 v176, v176 clamp
v_exp_f32 v177, v177 clamp
v_exp_f32 v178, v178 clamp
v_exp_f32 v179, v179 clamp
v_max_f32_e64 v89, s62, v89
v_max_f32_e64 v90, s62, v90
v_max_f32_e64 v91, s62, v91
v_permlane16_swap_b32 v128, v130
v_permlane16_swap_b32 v129, v131
buffer_store_dwordx4 v[128:131], v5, s[8:11], s55 offen offset:0 sc1
v_pk_add_f32 v[88:89], v[88:89], v[176:177]
v_pk_add_f32 v[90:91], v[90:91], v[178:179]
v_cvt_pk_bf16_f32 v132, v88, v89
v_cvt_pk_bf16_f32 v133, v90, v91
v_pk_mul_f32 v[176:177], v[92:93], s[60:61]
v_pk_mul_f32 v[178:179], v[94:95], s[60:61]
v_max_f32_e64 v92, s62, v92
v_exp_f32 v176, v176 clamp
v_exp_f32 v177, v177 clamp
v_exp_f32 v178, v178 clamp
v_exp_f32 v179, v179 clamp
v_max_f32_e64 v93, s62, v93
v_max_f32_e64 v94, s62, v94
v_max_f32_e64 v95, s62, v95
v_pk_add_f32 v[92:93], v[92:93], v[176:177]
v_pk_add_f32 v[94:95], v[94:95], v[178:179]
v_cvt_pk_bf16_f32 v134, v92, v93
v_cvt_pk_bf16_f32 v135, v94, v95
s_nop 0
v_permlane16_swap_b32 v132, v134
v_permlane16_swap_b32 v133, v135
buffer_store_dwordx4 v[132:135], v5, s[8:11], s55 offen offset:1024 sc1
s_lshl_b32 s50, s46, 9
s_add_u32 s50, s50, 3227648
s_lshl_b32 s51, s49, 7
s_add_u32 s66, s50, s51
s_branch LG1_r5
LG1_red:
s_mul_i32 s58, s49, 6784
s_add_u32 s58, s58, 3145728
s_add_u32 s8, s40, s58
s_addc_u32 s9, s41, 0
s_mov_b32 s10, 6720
s_mov_b32 s11, 0x20000
s_mov_b64 exec, -1
s_movk_i32 s59, 4096
v_lshlrev_b32 v2, 2, v0
v_add_u32 v3, 0, v2
s_waitcnt lgkmcnt(0)
s_barrier
ds_read_b32 v24, v3 offset:0
ds_read_b32 v25, v3 offset:6720
ds_read_b32 v26, v3 offset:13440
ds_read_b32 v27, v3 offset:20160
ds_read_b32 v28, v3 offset:2048
ds_read_b32 v29, v3 offset:8768
ds_read_b32 v30, v3 offset:15488
ds_read_b32 v31, v3 offset:22208
ds_read_b32 v32, v3 offset:4096
ds_read_b32 v33, v3 offset:10816
ds_read_b32 v34, v3 offset:17536
ds_read_b32 v35, v3 offset:24256
ds_read_b32 v36, v3 offset:6144
ds_read_b32 v37, v3 offset:12864
ds_read_b32 v38, v3 offset:19584
ds_read_b32 v39, v3 offset:26304
s_waitcnt lgkmcnt(12)
v_add_f32 v24, v24, v25
v_add_f32 v26, v26, v27
v_add_f32 v24, v24, v26
buffer_atomic_add_f32 v24, v2, s[8:11], 0 offen offset:0
s_waitcnt lgkmcnt(8)
v_add_f32 v28, v28, v29
v_add_f32 v30, v30, v31
v_add_f32 v28, v28, v30
buffer_atomic_add_f32 v28, v2, s[8:11], 0 offen offset:2048
s_waitcnt lgkmcnt(4)
v_add_f32 v32, v32, v33
v_add_f32 v34, v34, v35
v_add_f32 v32, v32, v34
buffer_atomic_add_f32 v32, v2, s[8:11], s59 offen offset:0
s_waitcnt lgkmcnt(0)
v_add_f32 v36, v36, v37
v_add_f32 v38, v38, v39
v_add_f32 v36, v36, v38
buffer_atomic_add_f32 v36, v2, s[8:11], s59 offen offset:2048
s_lshl_b32 s50, s49, 4
s_add_u32 s50, s50, s46
s_lshl_b32 s66, s50, 7
s_add_u32 s66, s66, 3211264
LG1_r5:
s_cmp_ge_u32 s45, 20
s_cbranch_scc1 LA2
LG2:
v_lshlrev_b32 v2, 4, v1
s_lshl_b32 s46, s44, 2
s_and_b32 s47, s45, 3
s_add_u32 s52, s46, s47
s_lshr_b32 s46, s52, 1
s_lshr_b32 s47, s45, 2
s_and_b32 s48, s3, 1
s_lshr_b32 s49, s3, 1
s_lshl_b32 s52, s52, 1
s_add_u32 s52, s52, s48
s_lshl_b32 s50, s46, 9
s_add_u32 s50, s50, 3227648
v_lshlrev_b32 v58, 7, v1
v_add_u32 v58, s50, v58
s_cmp_lg_u32 s3, 3
s_cbranch_scc1 LG2_ppa
s_mov_b64 exec, 15
global_load_dwordx2 v[56:57], v58, s[40:41] sc1
s_mov_b64 exec, -1
LG2_ppa:
s_add_u32 s4, s40, 0
s_addc_u32 s5, s41, 0
s_mov_b32 s6, 2621440
s_mov_b32 s7, 0x20000
s_and_b32 s53, s52, -2
s_mul_i32 s53, s53, 40960
s_mul_i32 s54, s3, 5120
s_add_u32 s92, s53, s54
s_add_u32 s93, s92, 4096
s_add_u32 s94, s92, 40960
s_add_u32 s95, s92, 45056
v_bfe_u32 v170, v1, 2, 2
v_lshrrev_b32 v171, 5, v1
v_xor_b32 v170, v170, v171
v_lshlrev_b32 v170, 6, v170
v_and_b32 v171, 3, v1
v_lshl_add_u32 v170, v171, 4, v170
v_lshrrev_b32 v171, 4, v1
v_mul_u32_u24 v171, 1280, v171
v_add_u32 v168, v170, v171
v_xor_b32 v169, 128, v168
s_mov_b32 s16, s34
s_mov_b32 s17, s35
s_mov_b32 s18, 819200
s_mov_b32 s19, 0x20000
s_lshl_b32 s56, s47, 8
s_mul_i32 s57, s49, 204800
s_add_u32 s56, s56, s57
s_mul_i32 s57, s48, 51200
s_add_u32 s56, s56, s57
s_add_u32 s56, s56, 102400
s_mul_i32 s57, s3, 10240
v_bfe_u32 v4, v1, 2, 2
v_lshrrev_b32 v6, 5, v1
v_lshl_add_u32 v7, v4, 1, v6
v_lshlrev_b32 v7, 8, v7
v_xor_b32 v5, s49, v4
v_lshl_add_u32 v7, v5, 6, v7
v_and_b32 v5, 1, v1
v_lshl_add_u32 v7, v5, 5, v7
v_and_b32 v5, 16, v1
v_add_u32 v7, v7, v5
v_and_b32 v5, 2, v1
v_lshl_add_u32 v14, v5, 2, v7
s_mul_i32 s50, s3, 10240
s_add_u32 s50, s50, 24
v_add_u32 v7, 0, v1
v_mul_u32_u24 v5, 205, v7
v_lshrrev_b32 v5, 10, v5
v_min_u32 v5, 21, v5
v_mul_u32_u24 v5, 40, v5
v_lshl_add_u32 v7, v7, 3, v5
v_add_u32 v9, s50, v7
v_add_u32 v7, 64, v1
v_mul_u32_u24 v5, 205, v7
v_lshrrev_b32 v5, 10, v5
v_min_u32 v5, 21, v5
v_mul_u32_u24 v5, 40, v5
v_lshl_add_u32 v7, v7, 3, v5
v_add_u32 v10, s50, v7
v_and_b32 v5, 3, v1
v_bfe_u32 v4, v1, 3, 2
v_lshl_add_u32 v4, v4, 2, v5
v_bfe_u32 v7, v1, 2, 1
v_lshl_add_u32 v7, v4, 1, v7
v_cmp_lt_u32 vcc, 10, v4
v_min_u32 v7, 20, v7
s_mul_i32 s58, s3, 10240
v_addc_co_u32 v7, vcc, 0, v7, vcc
v_mul_u32_u24 v7, 80, v7
v_lshl_add_u32 v7, v6, 4, v7
s_add_u32 s58, s58, 64
v_add_u32 v13, s58, v7
s_mul_i32 s58, s48, 40960
s_add_u32 s58, s58, 81920
v_add_u32 v4, s58, v2
s_mul_i32 s59, s3, 5120
s_add_u32 s59, s59, 81920
v_add_u32 v8, s59, v2
s_mov_b32 s62, 897988541
s_mul_i32 s51, s3, 6784
s_add_u32 s51, s51, 3145728
s_add_u32 s8, s40, s51
s_addc_u32 s9, s41, 0
s_mov_b32 s10, 6720
s_mov_b32 s11, 0x20000
s_movk_i32 s60, 3360
v_min_u32 v3, 40, v1
v_lshlrev_b32 v3, 4, v3
v_and_b32 v5, 31, v1
v_mul_u32_u24 v172, 80, v5
v_lshl_add_u32 v172, v6, 5, v172
s_mul_i32 s58, s3, 10240
s_add_u32 s58, s58, 81920
v_add_u32 v172, s58, v172
v_lshrrev_b32 v5, 2, v1
v_and_b32 v7, 3, v1
v_mul_u32_u24 v173, 80, v5
v_lshl_add_u32 v173, v7, 4, v173
v_add_u32 v173, s58, v173
v_mul_u32_u24 v5, 2560, v5
v_lshl_add_u32 v5, v7, 4, v5
s_mul_i32 s59, s52, 81920
s_lshl_b32 s58, s47, 8
s_add_u32 s59, s59, s58
s_lshl_b32 s58, s49, 6
s_add_u32 s59, s59, s58
s_add_u32 s59, s59, 1280
s_mov_b32 s12, s36
s_mov_b32 s13, s37
s_mov_b32 s14, 5242880
s_mov_b32 s15, 0x20000
s_waitcnt vmcnt(0)
s_barrier
s_cmp_lg_u32 s3, 0
s_cbranch_scc1 LG2_e1
s_cmp_eq_u32 s66, 0
s_cbranch_scc1 LG2_e1
v_mov_b32 v64, s68
v_mov_b32 v65, s69
v_mov_b32 v66, s66
s_mov_b64 exec, 1
global_store_dwordx2 v66, v[64:65], s[40:41] sc1
s_mov_b64 exec, -1
LG2_e1:
s_cmp_lg_u32 s3, 3
s_cbranch_scc1 LG2_ppb
s_mov_b64 exec, 15
s_mov_b32 s67, 0
s_branch Lpc6
Lpl6:
global_load_dwordx2 v[56:57], v58, s[40:41] sc1
s_waitcnt vmcnt(0)
Lpc6:
v_cmp_ne_u64 vcc, s[68:69], v[56:57]
s_add_u32 s67, s67, 1
s_nop 3
s_cbranch_vccz Lpe6
s_sleep 4
s_cmp_lt_u32 s67, 0x40000
s_cbranch_scc1 Lpl6
Lpe6:
s_mov_b64 exec, -1
LG2_ppb:
s_barrier
buffer_load_dwordx4 v[16:19], v2, s[4:7], s92 offen offset:0 sc1
buffer_load_dwordx4 v[20:23], v2, s[4:7], s92 offen offset:1024 sc1
buffer_load_dwordx4 v[36:39], v2, s[4:7], s94 offen offset:0 sc1
buffer_load_dwordx4 v[40:43], v2, s[4:7], s94 offen offset:1024 sc1
buffer_load_dwordx4 v[24:27], v2, s[4:7], s92 offen offset:2048 sc1
buffer_load_dwordx4 v[44:47], v2, s[4:7], s94 offen offset:2048 sc1
buffer_load_dwordx4 v[28:31], v2, s[4:7], s92 offen offset:3072 sc1
buffer_load_dwordx4 v[48:51], v2, s[4:7], s94 offen offset:3072 sc1
buffer_load_dwordx4 v[32:35], v2, s[4:7], s93 offen offset:0 sc1
buffer_load_dwordx4 v[52:55], v2, s[4:7], s95 offen offset:0 sc1
v_add_u32 v15, 81920, v14
v_add_u32 v12, 122880, v14
ds_read_b64_tr_b16 v[176:177], v15 offset:0
ds_read_b64_tr_b16 v[178:179], v15 offset:2048
ds_read_b64_tr_b16 v[180:181], v15 offset:4096
ds_read_b64_tr_b16 v[182:183], v15 offset:6144
ds_read_b64_tr_b16 v[184:185], v15 offset:8192
ds_read_b64_tr_b16 v[186:187], v15 offset:10240
ds_read_b64_tr_b16 v[188:189], v15 offset:12288
ds_read_b64_tr_b16 v[190:191], v15 offset:14336
ds_read_b64_tr_b16 v[192:193], v15 offset:16384
ds_read_b64_tr_b16 v[194:195], v15 offset:18432
ds_read_b64_tr_b16 v[196:197], v15 offset:20480
ds_read_b64_tr_b16 v[198:199], v15 offset:22528
ds_read_b64_tr_b16 v[200:201], v15 offset:24576
ds_read_b64_tr_b16 v[202:203], v15 offset:26624
ds_read_b64_tr_b16 v[204:205], v15 offset:28672
ds_read_b64_tr_b16 v[206:207], v15 offset:30720
ds_read_b64_tr_b16 v[208:209], v15 offset:32768
ds_read_b64_tr_b16 v[210:211], v15 offset:34816
ds_read_b64_tr_b16 v[212:213], v15 offset:36864
ds_read_b64_tr_b16 v[214:215], v15 offset:38912
ds_read_b64_tr_b16 v[216:217], v12 offset:0
ds_read_b64_tr_b16 v[218:219], v12 offset:2048
ds_read_b64_tr_b16 v[220:221], v12 offset:4096
ds_read_b64_tr_b16 v[222:223], v12 offset:6144
ds_read_b64_tr_b16 v[224:225], v12 offset:8192
ds_read_b64_tr_b16 v[226:227], v12 offset:10240
ds_read_b64_tr_b16 v[228:229], v12 offset:12288
ds_read_b64_tr_b16 v[230:231], v12 offset:14336
ds_read_b64_tr_b16 v[232:233], v12 offset:16384
ds_read_b64_tr_b16 v[234:235], v12 offset:18432
ds_read_b64_tr_b16 v[236:237], v12 offset:20480
ds_read_b64_tr_b16 v[238:239], v12 offset:22528
ds_read_b64_tr_b16 v[240:241], v12 offset:24576
ds_read_b64_tr_b16 v[242:243], v12 offset:26624
ds_read_b64_tr_b16 v[244:245], v12 offset:28672
ds_read_b64_tr_b16 v[246:247], v12 offset:30720
ds_read_b64_tr_b16 v[248:249], v12 offset:32768
ds_read_b64_tr_b16 v[250:251], v12 offset:34816
ds_read_b64_tr_b16 v[252:253], v12 offset:36864
ds_read_b64_tr_b16 v[254:255], v12 offset:38912
v_add_u32 v12, 40960, v14
v_mov_b32 v56, 0
v_mov_b32 v57, 0
v_lshlrev_b32 v62, 7, v1
s_lshl_b32 s50, s3, 11
s_add_u32 s50, s50, 3211264
v_add_u32 v62, s50, v62
ds_write_b64 v9, v[56:57] offset:0
ds_write_b64 v9, v[56:57] offset:1816
ds_write_b64 v9, v[56:57] offset:3632
ds_write_b64 v9, v[56:57] offset:5448
s_mov_b32 exec_hi, 0x3fffff
ds_write_b64 v10, v[56:57] offset:0
ds_write_b64 v10, v[56:57] offset:1816
ds_write_b64 v10, v[56:57] offset:3632
ds_write_b64 v10, v[56:57] offset:5448
s_waitcnt lgkmcnt(8)
s_barrier
s_mov_b64 exec, 0xffff
s_mov_b32 s67, 0
Lpl7:
global_load_dwordx2 v[60:61], v62, s[40:41] sc1
s_waitcnt vmcnt(0)
Lpc7:
v_cmp_ne_u64 vcc, s[68:69], v[60:61]
s_add_u32 s67, s67, 1
s_nop 3
s_cbranch_vccz Lpe7
s_sleep 2
s_cmp_lt_u32 s67, 0x40000
s_cbranch_scc1 Lpl7
Lpe7:
s_mov_b64 exec, -1
buffer_load_dwordx4 v[136:139], v2, s[8:11], 0 offen offset:0 sc1
buffer_load_dwordx4 v[140:143], v3, s[8:11], 0 offen offset:1024 sc1
buffer_load_dwordx4 v[144:147], v2, s[8:11], 0 offen offset:1680 sc1
buffer_load_dwordx4 v[148:151], v3, s[8:11], 0 offen offset:2704 sc1
buffer_load_dwordx4 v[152:155], v2, s[8:11], s60 offen offset:0 sc1
buffer_load_dwordx4 v[156:159], v3, s[8:11], s60 offen offset:1024 sc1
buffer_load_dwordx4 v[160:163], v2, s[8:11], s60 offen offset:1680 sc1
buffer_load_dwordx4 v[164:167], v3, s[8:11], s60 offen offset:2704 sc1
s_waitcnt vmcnt(7)
v_cvt_pk_bf16_f32 v136, v136, v137
v_cvt_pk_bf16_f32 v137, v138, v139
ds_write_b64 v9, v[136:137] offset:40
s_waitcnt vmcnt(6)
v_cvt_pk_bf16_f32 v140, v140, v141
v_cvt_pk_bf16_f32 v141, v142, v143
s_mov_b32 exec_hi, 0x1ff
ds_write_b64 v10, v[140:141] offset:40
s_mov_b32 exec_hi, -1
ds_read_b128 v[104:107], v13 offset:0
ds_read_b128 v[108:111], v13 offset:32
s_waitcnt vmcnt(5)
v_cvt_pk_bf16_f32 v144, v144, v145
v_cvt_pk_bf16_f32 v145, v146, v147
ds_write_b64 v9, v[144:145] offset:1856
s_waitcnt vmcnt(4)
v_cvt_pk_bf16_f32 v148, v148, v149
v_cvt_pk_bf16_f32 v149, v150, v151
s_mov_b32 exec_hi, 0x1ff
ds_write_b64 v10, v[148:149] offset:1856
s_mov_b32 exec_hi, -1
ds_read_b128 v[112:115], v13 offset:1808
ds_read_b128 v[116:119], v13 offset:1840
s_waitcnt lgkmcnt(5)
v_mfma_f32_32x32x16_bf16 v[56:71], v[104:107], v[16:19], 0
s_waitcnt lgkmcnt(4)
v_mfma_f32_32x32x16_bf16 v[56:71], v[108:111], v[20:23], v[56:71]
s_waitcnt vmcnt(3)
v_cvt_pk_bf16_f32 v152, v152, v153
v_cvt_pk_bf16_f32 v153, v154, v155
ds_write_b64 v9, v[152:153] offset:3672
s_waitcnt vmcnt(2)
v_cvt_pk_bf16_f32 v156, v156, v157
v_cvt_pk_bf16_f32 v157, v158, v159
s_mov_b32 exec_hi, 0x1ff
ds_write_b64 v10, v[156:157] offset:3672
s_mov_b32 exec_hi, -1
ds_read_b128 v[120:123], v13 offset:3616
ds_read_b128 v[124:127], v13 offset:3648
v_mfma_f32_32x32x16_bf16 v[72:87], v[104:107], v[36:39], 0
v_mfma_f32_32x32x16_bf16 v[72:87], v[108:111], v[40:43], v[72:87]
s_waitcnt vmcnt(1)
v_cvt_pk_bf16_f32 v160, v160, v161
v_cvt_pk_bf16_f32 v161, v162, v163
ds_write_b64 v9, v[160:161] offset:5488
s_waitcnt vmcnt(0)
v_cvt_pk_bf16_f32 v164, v164, v165
v_cvt_pk_bf16_f32 v165, v166, v167
s_mov_b32 exec_hi, 0x1ff
ds_write_b64 v10, v[164:165] offset:5488
s_mov_b32 exec_hi, -1
ds_read_b128 v[128:131], v13 offset:5424
ds_read_b128 v[132:135], v13 offset:5456
s_waitcnt lgkmcnt(9)
v_mfma_f32_32x32x16_bf16 v[88:103], v[112:115], v[20:23], 0
v_add_f32 v6, s62, v66
v_rcp_f32 v6, v6
s_nop 0
v_mul_f32 v56, v56, v6
v_mul_f32 v57, v57, v6
v_cvt_pk_bf16_f32 v16, v56, v57
v_mul_f32 v58, v58, v6
v_mul_f32 v59, v59, v6
v_cvt_pk_bf16_f32 v17, v58, v59
v_mul_f32 v60, v60, v6
v_mul_f32 v61, v61, v6
s_waitcnt lgkmcnt(8)
v_mfma_f32_32x32x16_bf16 v[88:103], v[116:119], v[24:27], v[88:103]
v_cvt_pk_bf16_f32 v18, v60, v61
v_add_f32 v7, s62, v82
v_rcp_f32 v7, v7
v_mul_f32 v62, v62, v6
v_mul_f32 v63, v63, v6
v_cvt_pk_bf16_f32 v19, v62, v63
ds_write_b128 v8, v[16:19] offset:0
v_mul_f32 v64, v64, v6
v_mul_f32 v65, v65, v6
v_cvt_pk_bf16_f32 v20, v64, v65
v_mfma_f32_32x32x16_bf16 v[56:71], v[112:115], v[40:43], 0
v_mul_f32 v72, v72, v7
v_mul_f32 v73, v73, v7
v_cvt_pk_bf16_f32 v36, v72, v73
v_mul_f32 v74, v74, v7
v_mul_f32 v75, v75, v7
v_cvt_pk_bf16_f32 v37, v74, v75
v_mul_f32 v76, v76, v7
v_mul_f32 v77, v77, v7
v_cvt_pk_bf16_f32 v38, v76, v77
v_mfma_f32_32x32x16_bf16 v[56:71], v[116:119], v[44:47], v[56:71]
v_add_f32 v6, s62, v98
v_rcp_f32 v6, v6
v_mul_f32 v78, v78, v7
v_mul_f32 v79, v79, v7
v_cvt_pk_bf16_f32 v39, v78, v79
ds_write_b128 v8, v[36:39] offset:40960
v_mul_f32 v80, v80, v7
v_mul_f32 v81, v81, v7
v_cvt_pk_bf16_f32 v40, v80, v81
s_waitcnt lgkmcnt(7)
v_mfma_f32_32x32x16_bf16 v[72:87], v[120:123], v[24:27], 0
v_mul_f32 v88, v88, v6
v_mul_f32 v89, v89, v6
v_cvt_pk_bf16_f32 v21, v88, v89
v_mul_f32 v90, v90, v6
v_mul_f32 v91, v91, v6
v_cvt_pk_bf16_f32 v22, v90, v91
v_mul_f32 v92, v92, v6
v_mul_f32 v93, v93, v6
v_cvt_pk_bf16_f32 v23, v92, v93
s_waitcnt lgkmcnt(6)
v_mfma_f32_32x32x16_bf16 v[72:87], v[124:127], v[28:31], v[72:87]
ds_write_b128 v8, v[20:23] offset:1024
v_add_f32 v7, s62, v66
v_rcp_f32 v7, v7
v_mul_f32 v94, v94, v6
v_mul_f32 v95, v95, v6
v_cvt_pk_bf16_f32 v24, v94, v95
v_mul_f32 v96, v96, v6
v_mul_f32 v97, v97, v6
v_cvt_pk_bf16_f32 v25, v96, v97
v_mfma_f32_32x32x16_bf16 v[88:103], v[120:123], v[44:47], 0
v_mul_f32 v56, v56, v7
v_mul_f32 v57, v57, v7
v_cvt_pk_bf16_f32 v41, v56, v57
v_mul_f32 v58, v58, v7
v_mul_f32 v59, v59, v7
v_cvt_pk_bf16_f32 v42, v58, v59
v_mul_f32 v60, v60, v7
v_mul_f32 v61, v61, v7
v_cvt_pk_bf16_f32 v43, v60, v61
v_mfma_f32_32x32x16_bf16 v[88:103], v[124:127], v[48:51], v[88:103]
ds_write_b128 v8, v[40:43] offset:41984
v_add_f32 v6, s62, v82
v_rcp_f32 v6, v6
v_mul_f32 v62, v62, v7
v_mul_f32 v63, v63, v7
v_cvt_pk_bf16_f32 v44, v62, v63
v_mul_f32 v64, v64, v7
v_mul_f32 v65, v65, v7
v_cvt_pk_bf16_f32 v45, v64, v65
s_waitcnt lgkmcnt(5)
v_mfma_f32_32x32x16_bf16 v[56:71], v[128:131], v[28:31], 0
v_mul_f32 v72, v72, v6
v_mul_f32 v73, v73, v6
v_cvt_pk_bf16_f32 v26, v72, v73
v_mul_f32 v74, v74, v6
v_mul_f32 v75, v75, v6
v_cvt_pk_bf16_f32 v27, v74, v75
ds_write_b128 v8, v[24:27] offset:2048
v_mul_f32 v76, v76, v6
v_mul_f32 v77, v77, v6
s_waitcnt lgkmcnt(5)
v_mfma_f32_32x32x16_bf16 v[56:71], v[132:135], v[32:35], v[56:71]
v_cvt_pk_bf16_f32 v28, v76, v77
v_add_f32 v7, s62, v98
v_rcp_f32 v7, v7
v_mul_f32 v78, v78, v6
v_mul_f32 v79, v79, v6
v_cvt_pk_bf16_f32 v29, v78, v79
v_mul_f32 v80, v80, v6
v_mul_f32 v81, v81, v6
v_cvt_pk_bf16_f32 v30, v80, v81
v_mfma_f32_32x32x16_bf16 v[72:87], v[128:131], v[48:51], 0
v_mul_f32 v88, v88, v7
v_mul_f32 v89, v89, v7
v_cvt_pk_bf16_f32 v46, v88, v89
v_mul_f32 v90, v90, v7
v_mul_f32 v91, v91, v7
v_cvt_pk_bf16_f32 v47, v90, v91
ds_write_b128 v8, v[44:47] offset:43008
v_mul_f32 v92, v92, v7
v_mul_f32 v93, v93, v7
v_mfma_f32_32x32x16_bf16 v[72:87], v[132:135], v[52:55], v[72:87]
v_cvt_pk_bf16_f32 v48, v92, v93
v_add_f32 v6, s62, v66
v_rcp_f32 v6, v6
v_mul_f32 v94, v94, v7
v_mul_f32 v95, v95, v7
v_cvt_pk_bf16_f32 v49, v94, v95
v_mul_f32 v96, v96, v7
v_mul_f32 v97, v97, v7
v_cvt_pk_bf16_f32 v50, v96, v97
v_mul_f32 v56, v56, v6
v_mul_f32 v57, v57, v6
v_cvt_pk_bf16_f32 v31, v56, v57
ds_write_b128 v8, v[28:31] offset:3072
v_mul_f32 v58, v58, v6
v_mul_f32 v59, v59, v6
v_cvt_pk_bf16_f32 v32, v58, v59
v_mul_f32 v60, v60, v6
v_mul_f32 v61, v61, v6
v_cvt_pk_bf16_f32 v33, v60, v61
v_add_f32 v7, s62, v82
v_rcp_f32 v7, v7
v_mul_f32 v62, v62, v6
v_mul_f32 v63, v63, v6
v_cvt_pk_bf16_f32 v34, v62, v63
v_mul_f32 v64, v64, v6
v_mul_f32 v65, v65, v6
v_cvt_pk_bf16_f32 v35, v64, v65
ds_write_b128 v8, v[32:35] offset:4096
v_mul_f32 v72, v72, v7
v_mul_f32 v73, v73, v7
v_cvt_pk_bf16_f32 v51, v72, v73
ds_write_b128 v8, v[48:51] offset:44032
v_mul_f32 v74, v74, v7
v_mul_f32 v75, v75, v7
v_cvt_pk_bf16_f32 v52, v74, v75
v_mul_f32 v76, v76, v7
v_mul_f32 v77, v77, v7
v_cvt_pk_bf16_f32 v53, v76, v77
v_mul_f32 v78, v78, v7
v_mul_f32 v79, v79, v7
v_cvt_pk_bf16_f32 v54, v78, v79
v_mul_f32 v80, v80, v7
v_mul_f32 v81, v81, v7
v_cvt_pk_bf16_f32 v55, v80, v81
ds_write_b128 v8, v[52:55] offset:45056
s_add_u32 m0, s57, 0
s_add_u32 s58, s56, 0
buffer_load_dwordx4 v168, s[16:19], s58 offen lds
s_add_u32 m0, s57, 1024
s_add_u32 s58, s56, 5120
buffer_load_dwordx4 v169, s[16:19], s58 offen lds
s_add_u32 m0, s57, 2048
s_add_u32 s58, s56, 10240
buffer_load_dwordx4 v168, s[16:19], s58 offen lds
s_add_u32 m0, s57, 3072
s_add_u32 s58, s56, 15360
buffer_load_dwordx4 v169, s[16:19], s58 offen lds
s_add_u32 m0, s57, 4096
s_add_u32 s58, s56, 20480
buffer_load_dwordx4 v168, s[16:19], s58 offen lds
s_add_u32 m0, s57, 5120
s_add_u32 s58, s56, 25600
buffer_load_dwordx4 v169, s[16:19], s58 offen lds
s_add_u32 m0, s57, 6144
s_add_u32 s58, s56, 30720
buffer_load_dwordx4 v168, s[16:19], s58 offen lds
s_add_u32 m0, s57, 7168
s_add_u32 s58, s56, 35840
buffer_load_dwordx4 v169, s[16:19], s58 offen lds
s_add_u32 m0, s57, 8192
s_add_u32 s58, s56, 40960
buffer_load_dwordx4 v168, s[16:19], s58 offen lds
s_add_u32 m0, s57, 9216
s_add_u32 s58, s56, 46080
buffer_load_dwordx4 v169, s[16:19], s58 offen lds
s_waitcnt lgkmcnt(0)
s_barrier
ds_read_b128 v[16:19], v4 offset:0
ds_read_b128 v[20:23], v4 offset:1024
ds_read_b128 v[24:27], v4 offset:2048
ds_read_b128 v[28:31], v4 offset:3072
s_waitcnt lgkmcnt(3)
v_mfma_f32_32x32x16_bf16 v[104:119], v[176:179], v[16:19], 0
ds_read_b128 v[32:35], v4 offset:4096
s_waitcnt lgkmcnt(3)
v_mfma_f32_32x32x16_bf16 v[104:119], v[180:183], v[20:23], v[104:119]
ds_read_b128 v[36:39], v4 offset:10240
s_waitcnt lgkmcnt(3)
v_mfma_f32_32x32x16_bf16 v[104:119], v[184:187], v[24:27], v[104:119]
ds_read_b128 v[40:43], v4 offset:11264
s_waitcnt lgkmcnt(3)
v_mfma_f32_32x32x16_bf16 v[104:119], v[188:191], v[28:31], v[104:119]
ds_read_b128 v[44:47], v4 offset:12288
s_waitcnt lgkmcnt(3)
v_mfma_f32_32x32x16_bf16 v[104:119], v[192:195], v[32:35], v[104:119]
ds_read_b128 v[48:51], v4 offset:13312
s_waitcnt lgkmcnt(3)
v_mfma_f32_32x32x16_bf16 v[104:119], v[196:199], v[36:39], v[104:119]
ds_read_b128 v[52:55], v4 offset:14336
s_waitcnt lgkmcnt(3)
v_mfma_f32_32x32x16_bf16 v[104:119], v[200:203], v[40:43], v[104:119]
ds_read_b128 v[16:19], v4 offset:20480
s_waitcnt lgkmcnt(3)
v_mfma_f32_32x32x16_bf16 v[104:119], v[204:207], v[44:47], v[104:119]
ds_read_b128 v[20:23], v4 offset:21504
s_waitcnt lgkmcnt(3)
v_mfma_f32_32x32x16_bf16 v[104:119], v[208:211], v[48:51], v[104:119]
ds_read_b128 v[24:27], v4 offset:22528
s_waitcnt lgkmcnt(3)
v_mfma_f32_32x32x16_bf16 v[104:119], v[212:215], v[52:55], v[104:119]
ds_read_b128 v[28:31], v4 offset:23552
s_waitcnt lgkmcnt(3)
v_mfma_f32_32x32x16_bf16 v[104:119], v[216:219], v[16:19], v[104:119]
ds_read_b128 v[32:35], v4 offset:24576
s_waitcnt lgkmcnt(3)
v_mfma_f32_32x32x16_bf16 v[104:119], v[220:223], v[20:23], v[104:119]
ds_read_b128 v[36:39], v4 offset:30720
s_waitcnt lgkmcnt(3)
v_mfma_f32_32x32x16_bf16 v[104:119], v[224:227], v[24:27], v[104:119]
ds_read_b128 v[40:43], v4 offset:31744
s_waitcnt lgkmcnt(3)
v_mfma_f32_32x32x16_bf16 v[104:119], v[228:231], v[28:31], v[104:119]
ds_read_b128 v[44:47], v4 offset:32768
s_waitcnt lgkmcnt(3)
v_mfma_f32_32x32x16_bf16 v[104:119], v[232:235], v[32:35], v[104:119]
ds_read_b128 v[48:51], v4 offset:33792
s_waitcnt lgkmcnt(3)
v_mfma_f32_32x32x16_bf16 v[104:119], v[236:239], v[36:39], v[104:119]
ds_read_b128 v[52:55], v4 offset:34816
s_waitcnt lgkmcnt(0)
s_waitcnt vmcnt(0)
s_barrier
v_mfma_f32_32x32x16_bf16 v[104:119], v[240:243], v[40:43], v[104:119]
ds_read_b128 v[16:19], v4 offset:5120
ds_read_b64_tr_b16 v[56:57], v14 offset:0
ds_read_b64_tr_b16 v[58:59], v14 offset:2048
v_mfma_f32_32x32x16_bf16 v[104:119], v[244:247], v[44:47], v[104:119]
ds_read_b128 v[20:23], v4 offset:6144
ds_read_b64_tr_b16 v[60:61], v14 offset:4096
ds_read_b64_tr_b16 v[62:63], v14 offset:6144
v_mfma_f32_32x32x16_bf16 v[104:119], v[248:251], v[48:51], v[104:119]
ds_read_b128 v[24:27], v4 offset:7168
ds_read_b64_tr_b16 v[64:65], v14 offset:8192
ds_read_b64_tr_b16 v[66:67], v14 offset:10240
v_mfma_f32_32x32x16_bf16 v[104:119], v[252:255], v[52:55], v[104:119]
ds_read_b128 v[28:31], v4 offset:8192
ds_read_b64_tr_b16 v[68:69], v14 offset:12288
ds_read_b64_tr_b16 v[70:71], v14 offset:14336
s_waitcnt lgkmcnt(11)
s_waitcnt lgkmcnt(9)
v_mfma_f32_32x32x16_bf16 v[104:119], v[56:59], v[16:19], v[104:119]
ds_read_b128 v[32:35], v4 offset:9216
ds_read_b64_tr_b16 v[72:73], v14 offset:16384
ds_read_b64_tr_b16 v[74:75], v14 offset:18432
s_waitcnt lgkmcnt(11)
s_waitcnt lgkmcnt(9)
v_mfma_f32_32x32x16_bf16 v[104:119], v[60:63], v[20:23], v[104:119]
ds_read_b128 v[36:39], v4 offset:15360
ds_read_b64_tr_b16 v[76:77], v14 offset:20480
ds_read_b64_tr_b16 v[78:79], v14 offset:22528
s_waitcnt lgkmcnt(11)
s_waitcnt lgkmcnt(9)
v_mfma_f32_32x32x16_bf16 v[104:119], v[64:67], v[24:27], v[104:119]
ds_read_b128 v[40:43], v4 offset:16384
ds_read_b64_tr_b16 v[80:81], v14 offset:24576
ds_read_b64_tr_b16 v[82:83], v14 offset:26624
s_waitcnt lgkmcnt(11)
s_waitcnt lgkmcnt(9)
v_mfma_f32_32x32x16_bf16 v[104:119], v[68:71], v[28:31], v[104:119]
ds_read_b128 v[44:47], v4 offset:17408
ds_read_b64_tr_b16 v[84:85], v14 offset:28672
ds_read_b64_tr_b16 v[86:87], v14 offset:30720
s_waitcnt lgkmcnt(11)
s_waitcnt lgkmcnt(9)
v_mfma_f32_32x32x16_bf16 v[104:119], v[72:75], v[32:35], v[104:119]
ds_read_b128 v[48:51], v4 offset:18432
ds_read_b64_tr_b16 v[88:89], v14 offset:32768
ds_read_b64_tr_b16 v[90:91], v14 offset:34816
s_waitcnt lgkmcnt(11)
s_waitcnt lgkmcnt(9)
v_mfma_f32_32x32x16_bf16 v[104:119], v[76:79], v[36:39], v[104:119]
ds_read_b128 v[52:55], v4 offset:19456
ds_read_b64_tr_b16 v[92:93], v14 offset:36864
ds_read_b64_tr_b16 v[94:95], v14 offset:38912
s_waitcnt lgkmcnt(11)
s_waitcnt lgkmcnt(9)
v_mfma_f32_32x32x16_bf16 v[104:119], v[80:83], v[40:43], v[104:119]
ds_read_b128 v[16:19], v4 offset:25600
ds_read_b64_tr_b16 v[96:97], v12 offset:0
ds_read_b64_tr_b16 v[98:99], v12 offset:2048
s_waitcnt lgkmcnt(11)
s_waitcnt lgkmcnt(9)
v_mfma_f32_32x32x16_bf16 v[104:119], v[84:87], v[44:47], v[104:119]
ds_read_b128 v[20:23], v4 offset:26624
ds_read_b64_tr_b16 v[100:101], v12 offset:4096
ds_read_b64_tr_b16 v[102:103], v12 offset:6144
s_waitcnt lgkmcnt(11)
s_waitcnt lgkmcnt(9)
v_mfma_f32_32x32x16_bf16 v[104:119], v[88:91], v[48:51], v[104:119]
ds_read_b128 v[24:27], v4 offset:27648
ds_read_b64_tr_b16 v[56:57], v12 offset:8192
ds_read_b64_tr_b16 v[58:59], v12 offset:10240
s_waitcnt lgkmcnt(11)
s_waitcnt lgkmcnt(9)
v_mfma_f32_32x32x16_bf16 v[104:119], v[92:95], v[52:55], v[104:119]
ds_read_b128 v[28:31], v4 offset:28672
ds_read_b64_tr_b16 v[60:61], v12 offset:12288
ds_read_b64_tr_b16 v[62:63], v12 offset:14336
s_waitcnt lgkmcnt(11)
s_waitcnt lgkmcnt(9)
v_mfma_f32_32x32x16_bf16 v[104:119], v[96:99], v[16:19], v[104:119]
ds_read_b128 v[32:35], v4 offset:29696
ds_read_b64_tr_b16 v[64:65], v12 offset:16384
ds_read_b64_tr_b16 v[66:67], v12 offset:18432
s_waitcnt lgkmcnt(11)
s_waitcnt lgkmcnt(9)
v_mfma_f32_32x32x16_bf16 v[104:119], v[100:103], v[20:23], v[104:119]
ds_read_b128 v[36:39], v4 offset:35840
ds_read_b64_tr_b16 v[68:69], v12 offset:20480
ds_read_b64_tr_b16 v[70:71], v12 offset:22528
s_waitcnt lgkmcnt(11)
s_waitcnt lgkmcnt(9)
v_mfma_f32_32x32x16_bf16 v[104:119], v[56:59], v[24:27], v[104:119]
ds_read_b128 v[40:43], v4 offset:36864
ds_read_b64_tr_b16 v[72:73], v12 offset:24576
ds_read_b64_tr_b16 v[74:75], v12 offset:26624
s_waitcnt lgkmcnt(11)
s_waitcnt lgkmcnt(9)
v_mfma_f32_32x32x16_bf16 v[104:119], v[60:63], v[28:31], v[104:119]
ds_read_b128 v[44:47], v4 offset:37888
ds_read_b64_tr_b16 v[76:77], v12 offset:28672
ds_read_b64_tr_b16 v[78:79], v12 offset:30720
s_waitcnt lgkmcnt(11)
s_waitcnt lgkmcnt(9)
v_mfma_f32_32x32x16_bf16 v[104:119], v[64:67], v[32:35], v[104:119]
ds_read_b128 v[48:51], v4 offset:38912
ds_read_b64_tr_b16 v[80:81], v12 offset:32768
ds_read_b64_tr_b16 v[82:83], v12 offset:34816
s_waitcnt lgkmcnt(11)
s_waitcnt lgkmcnt(9)
v_mfma_f32_32x32x16_bf16 v[104:119], v[68:71], v[36:39], v[104:119]
ds_read_b128 v[52:55], v4 offset:39936
ds_read_b64_tr_b16 v[84:85], v12 offset:36864
ds_read_b64_tr_b16 v[86:87], v12 offset:38912
s_waitcnt lgkmcnt(11)
s_waitcnt lgkmcnt(9)
v_mfma_f32_32x32x16_bf16 v[104:119], v[72:75], v[40:43], v[104:119]
s_waitcnt lgkmcnt(8)
s_waitcnt lgkmcnt(6)
v_mfma_f32_32x32x16_bf16 v[104:119], v[76:79], v[44:47], v[104:119]
s_waitcnt lgkmcnt(5)
s_waitcnt lgkmcnt(3)
v_mfma_f32_32x32x16_bf16 v[104:119], v[80:83], v[48:51], v[104:119]
s_waitcnt lgkmcnt(2)
s_waitcnt lgkmcnt(0)
v_mfma_f32_32x32x16_bf16 v[104:119], v[84:87], v[52:55], v[104:119]
s_nop 11
v_cvt_pk_bf16_f32 v16, v104, v105
v_cvt_pk_bf16_f32 v17, v106, v107
v_cvt_pk_bf16_f32 v18, v108, v109
v_cvt_pk_bf16_f32 v19, v110, v111
v_cvt_pk_bf16_f32 v20, v112, v113
v_cvt_pk_bf16_f32 v21, v114, v115
v_cvt_pk_bf16_f32 v22, v116, v117
v_cvt_pk_bf16_f32 v23, v118, v119
ds_write_b128 v172, v[16:19]
ds_write_b128 v172, v[20:23] offset:16
ds_read_b128 v[24:27], v173
ds_read_b128 v[28:31], v173 offset:1280
s_add_u32 s58, s59, 40960
s_waitcnt lgkmcnt(1)
buffer_store_dwordx4 v[24:27], v5, s[12:15], s59 offen nt
s_waitcnt lgkmcnt(0)
buffer_store_dwordx4 v[28:31], v5, s[12:15], s58 offen nt
s_endpgm
Lend:
s_endpgm
LA_from1:
s_lshl_b32 s42, s44, 5
s_sub_u32 s46, s45, 24
s_lshl_b32 s46, s46, 2
s_add_u32 s42, s42, s46
s_mov_b32 s63, 1
s_lshl_b32 s50, s2, 3
s_add_u32 s50, s50, s3
s_cmp_lg_u32 s50, 7
s_cbranch_scc1 LA_nt
s_memrealtime s[92:93]
v_mov_b32 v10, 0
s_waitcnt lgkmcnt(0)
s_or_b32 s50, s92, 1
v_mov_b32 v8, s50
v_mov_b32 v9, s93
s_mov_b64 exec, 1
global_store_dwordx2 v10, v[8:9], s[38:39] offset:128 sc0 sc1
s_mov_b64 exec, -1
LA_nt:
s_sub_u32 s95, s45, 24
s_lshl_b32 s95, s95, 3
s_add_u32 s95, s95, s44
s_and_b32 s61, s95, 1
s_lshr_b32 s95, s95, 1
LA:
s_and_b32 s46, s3, 3
s_lshr_b32 s47, s3, 2
s_add_u32 s48, s42, s46
s_lshl_b32 s49, s48, 8
s_lshl_b32 s50, s47, 7
s_add_u32 s49, s49, s50
v_lshlrev_b32 v4, 1, v1
v_add_u32 v4, s49, v4
s_lshl_b32 s50, s48, 1
v_mov_b32 v5, s50
s_waitcnt lgkmcnt(0)
global_load_ushort v20, v5, s[26:27]
global_load_ushort v16, v4, s[18:19]
global_load_ushort v17, v4, s[20:21]
global_load_ushort v18, v4, s[22:23]
global_load_ushort v19, v4, s[24:25]
global_load_ushort v21, v5, s[28:29]
v_and_b32 v15, 31, v1
v_lshlrev_b32 v15, 7, v15
s_lshr_b32 s50, s42, 6
s_lshl_b32 s50, s50, 12
s_add_u32 s50, s50, 3235840
v_add_u32 v15, s50, v15
s_mov_b32 s60, 0
s_cmp_eq_u32 s63, 0
s_cbranch_scc1 LA_pre
s_cmp_ge_u32 s3, 2
s_cbranch_scc1 LA_pre1
s_mov_b32 s60, 1
s_lshl_b32 s94, s61, 1
s_add_u32 s94, s94, s3
v_and_b32 v152, 7, v1
v_lshrrev_b32 v153, 3, v1
v_and_b32 v154, 1, v153
v_lshlrev_b32 v154, 5, v154
v_lshrrev_b32 v155, 4, v1
v_add_u32 v154, v154, v155
v_mul_u32_u24 v154, 1280, v154
v_lshl_add_u32 v154, v152, 4, v154
s_mul_i32 s92, s95, 81920
s_lshl_b32 s93, s94, 7
s_add_u32 s92, s92, s93
s_mov_b32 s96, s16
s_mov_b32 s97, s17
s_mov_b32 s98, 2621440
s_mov_b32 s99, 0x20000
buffer_load_dwordx4 v[160:163], v154, s[96:99], s92 offen
s_add_u32 s92, s92, 5120
buffer_load_dwordx4 v[164:167], v154, s[96:99], s92 offen
s_add_u32 s92, s92, 5120
buffer_load_dwordx4 v[168:171], v154, s[96:99], s92 offen
s_add_u32 s92, s92, 5120
buffer_load_dwordx4 v[172:175], v154, s[96:99], s92 offen
s_add_u32 s92, s92, 5120
buffer_load_dwordx4 v[176:179], v154, s[96:99], s92 offen
s_add_u32 s92, s92, 5120
buffer_load_dwordx4 v[180:183], v154, s[96:99], s92 offen
s_add_u32 s92, s92, 5120
buffer_load_dwordx4 v[184:187], v154, s[96:99], s92 offen
s_add_u32 s92, s92, 5120
buffer_load_dwordx4 v[188:191], v154, s[96:99], s92 offen
LA_pre1:
LA_pre:
s_add_u32 s12, s40, 4194304
s_addc_u32 s13, s41, 0
s_mov_b32 s14, 2621440
s_mov_b32 s15, 0x20000
v_bfe_u32 v12, v0, 1, 2
v_mul_u32_u24 v12, 1184, v12
v_bfe_u32 v13, v0, 3, 5
v_lshl_add_u32 v12, v13, 5, v12
v_and_b32 v13, 1, v0
v_lshl_add_u32 v12, v13, 4, v12
s_mul_i32 s50, s47, 4736
v_add_u32 v12, s50, v12
v_lshlrev_b32 v55, 4, v0
v_mov_b32 v158, 0
s_lshl_b32 s56, s42, 12
s_add_u32 s57, s56, 8192
LA_setup:
v_lshrrev_b32 v2, 5, v0
v_mul_u32_u24 v2, 1184, v2
v_and_b32 v3, 31, v0
v_lshl_add_u32 v2, v3, 2, v2
v_mov_b32 v14, 0
v_mov_b32 v56, v2
s_mul_i32 s52, s3, 16416
s_add_u32 s52, s52, 18944
s_mov_b32 m0, s52
s_mov_b32 s53, 1069066811
s_mov_b32 s54, 1042479491
s_mov_b32 s55, 0x43000000
v_and_b32 v22, 15, v1
v_lshrrev_b32 v23, 4, v1
v_mul_u32_u24 v54, 288, v22
v_lshl_add_u32 v54, v23, 4, v54
v_add_u32 v54, s52, v54
v_lshrrev_b32 v2, 1, v23
v_and_b32 v3, 1, v23
v_lshlrev_b32 v8, 9, v2
v_lshl_add_u32 v8, v3, 4, v8
v_lshl_add_u32 v8, v22, 5, v8
v_add_u32 v8, s52, v8
v_sub_u32 v3, 4, v2
v_lshlrev_b32 v9, v3, v22
v_lshl_add_u32 v9, v23, 8, v9
v_add_u32 v9, s52, v9
v_mul_u32_u24 v3, 120, v2
v_add3_u32 v10, v9, v3, 8
v_lshlrev_b32 v11, 8, v23
v_lshl_add_u32 v11, v22, 2, v11
v_add_u32 v11, s52, v11
v_add_u32 v11, 2048, v11
s_cmp_ge_u32 s3, 4
s_cbranch_scc1 LA_hset
v_lshlrev_b32 v2, 4, v1
v_add_u32 v2, s52, v2
v_lshlrev_b32 v3, 3, v1
v_add_u32 v3, s52, v3
v_and_b32 v13, 7, v1
v_lshlrev_b32 v13, 2, v13
v_add_u32 v13, s52, v13
v_and_b32 v4, 3, v1
v_bfe_u32 v5, v1, 2, 2
v_sub_u32 v4, v4, v5
v_lshlrev_b32 v5, 3, v23
v_sub_u32 v4, v4, v5
v_add_u32 v4, 28, v4
v_lshlrev_b32 v4, 3, v4
v_add_u32 v4, s52, v4
s_mul_i32 s50, s3, 4736
v_lshlrev_b32 v5, 3, v22
v_lshl_add_u32 v5, v23, 4, v5
v_add_u32 v5, s50, v5
v_add_u32 v6, 16, v1
v_subrev_u32 v7, 47, v1
v_cmp_lt_u32 vcc, 47, v1
v_cmp_eq_u32 s[58:59], 0, v1
s_nop 0
v_cndmask_b32 v6, v6, v7, vcc
v_cmp_eq_u32 vcc, 63, v1
v_lshlrev_b32 v7, 5, v1
v_add_u32 v7, s52, v7
v_cndmask_b32 v6, v6, 64, vcc
v_lshlrev_b32 v6, 4, v6
v_add_u32 v6, s52, v6
s_branch LA_kgen
LA_hset:
v_lshlrev_b32 v5, 2, v1
s_lshl_b32 s50, s46, 8
s_add_u32 s50, s50, 18944
v_add_u32 v5, s50, v5
v_lshrrev_b32 v7, 2, v1
v_lshlrev_b32 v7, 4, v7
v_and_b32 v6, 3, v1
v_add_u32 v7, v7, v6
v_mul_u32_u24 v7, 2560, v7
s_mul_i32 s62, s46, 10240
s_lshl_b32 s51, s42, 1
s_add_u32 s62, s62, s51
LA_kgen:
s_cmp_eq_u32 s63, 1
s_cbranch_scc1 LA_kg1
s_waitcnt vmcnt(0)
s_barrier
s_cmp_lg_u32 s3, 0
s_cbranch_scc1 LA_kg3
v_mov_b32 v150, s68
v_mov_b32 v151, s69
v_mov_b32 v152, s66
s_mov_b64 exec, 1
global_store_dwordx2 v152, v[150:151], s[40:41] sc1
s_mov_b64 exec, -1
LA_kg3:
buffer_load_dwordx4 v[140:143], v55, s[12:15], s56 offen sc1
buffer_load_dwordx4 v[144:147], v55, s[12:15], s57 offen sc1
s_cmp_lt_u32 s3, 4
s_cbranch_scc1 LA_kg2
s_mov_b32 s96, s34
s_mov_b32 s97, s35
s_mov_b32 s98, 819200
s_mov_b32 s99, 0x20000
s_sub_u32 s50, s45, 20
s_mul_i32 s50, s50, 8576
s_mul_i32 s51, s46, 204800
s_add_u32 s50, s50, s51
s_add_u32 s50, s50, 102400
v_lshlrev_b32 v152, 7, v1
buffer_load_dword v153, v152, s[96:99], s50 offen
buffer_load_dword v154, v152, s[96:99], s50 offen offset:384
s_branch LA_kg2
LA_kg1:
s_waitcnt vmcnt(8)
s_cmp_eq_u32 s60, 1
s_cbranch_scc1 LA_kg2
s_waitcnt vmcnt(0)
s_cmp_ge_u32 s3, 5
s_cbranch_scc1 LA_kg4
s_mov_b32 s60, 1
s_mul_i32 s94, s61, 3
s_add_u32 s94, s94, s3
s_add_u32 s94, s94, 2
v_and_b32 v152, 7, v1
v_lshrrev_b32 v153, 3, v1
v_and_b32 v154, 1, v153
v_lshlrev_b32 v154, 5, v154
v_lshrrev_b32 v155, 4, v1
v_add_u32 v154, v154, v155
v_mul_u32_u24 v154, 1280, v154
v_lshl_add_u32 v154, v152, 4, v154
s_mul_i32 s92, s95, 81920
s_lshl_b32 s93, s94, 7
s_add_u32 s92, s92, s93
s_mov_b32 s96, s16
s_mov_b32 s97, s17
s_mov_b32 s98, 2621440
s_mov_b32 s99, 0x20000
buffer_load_dwordx4 v[160:163], v154, s[96:99], s92 offen
s_add_u32 s92, s92, 5120
buffer_load_dwordx4 v[164:167], v154, s[96:99], s92 offen
s_add_u32 s92, s92, 5120
buffer_load_dwordx4 v[168:171], v154, s[96:99], s92 offen
s_add_u32 s92, s92, 5120
buffer_load_dwordx4 v[172:175], v154, s[96:99], s92 offen
s_add_u32 s92, s92, 5120
buffer_load_dwordx4 v[176:179], v154, s[96:99], s92 offen
s_add_u32 s92, s92, 5120
buffer_load_dwordx4 v[180:183], v154, s[96:99], s92 offen
s_add_u32 s92, s92, 5120
buffer_load_dwordx4 v[184:187], v154, s[96:99], s92 offen
s_add_u32 s92, s92, 5120
buffer_load_dwordx4 v[188:191], v154, s[96:99], s92 offen
s_branch LA_kg2
LA_kg4:
s_cmp_lg_u32 s3, 6
s_cbranch_scc1 LA_kg2
s_cmp_lg_u32 s45, 24
s_cbranch_scc1 LA_kg2
s_mul_i32 s50, s44, 6784
s_add_u32 s50, s50, 3145728
s_add_u32 s8, s40, s50
s_addc_u32 s9, s41, 0
s_mov_b32 s10, 6720
s_mov_b32 s11, 0x20000
v_lshlrev_b32 v150, 4, v1
v_mov_b32 v160, 0
v_mov_b32 v161, 0
v_mov_b32 v162, 0
v_mov_b32 v163, 0
s_mov_b32 s50, 0
LA_zl:
buffer_store_dwordx4 v[160:163], v150, s[8:11], s50 offen sc0 sc1
s_add_u32 s50, s50, 1024
s_cmp_lt_u32 s50, 6720
s_cbranch_scc1 LA_zl
s_mov_b32 s60, 2
LA_kg2:
ds_write_b32 v56, v14 offset:0
v_lshlrev_b32 v20, 16, v20
v_lshlrev_b32 v16, 16, v16
v_lshlrev_b32 v17, 16, v17
v_lshlrev_b32 v18, 16, v18
v_lshlrev_b32 v19, 16, v19
v_lshlrev_b32 v21, 16, v21
v_mul_f32 v20, s53, v20
v_mul_f32 v16, s53, v16
v_exp_f32 v20, v20
v_exp_f32 v16, v16
v_mul_f32 v17, s54, v17
v_cvt_pk_bf16_f32 v16, v20, v16
v_lshlrev_b32 v20, 16, v16
v_and_b32 v16, 0xffff0000, v16
v_mul_f32 v16, v16, v20
v_mul_f32 v17, v17, v20
v_mul_f32_e64 v16, -v16, s53
v_add_f32 v20, v20, v20
v_mul_f32 v34, v18, v20
v_mul_f32 v35, v19, v20
v_mul_f32 v18, s55, v16
v_mul_f32 v19, s55, v17
v_fract_f32 v17, v17
v_fract_f32 v19, v19
v_exp_f32 v16, v16
v_cos_f32 v24, v17
v_sin_f32 v25, v17
v_exp_f32 v18, v18
v_cos_f32 v32, v19
v_sin_f32 v33, v19
v_mul_f32 v24, v24, v16
v_mul_f32 v25, v25, v16
v_mul_f32 v32, v32, v18
v_mul_f32 v33, v33, v18
.p2align 3
v_pk_mul_f32 v[26:27], v[24:25], v[24:25] op_sel_hi:[1,0]
v_pk_fma_f32 v[26:27], v[24:25], v[24:25], v[26:27] op_sel:[1,1,0] op_sel_hi:[0,1,1] neg_lo:[1,0,0]
v_pk_mul_f32 v[28:29], v[26:27], v[26:27] op_sel_hi:[1,0]
v_pk_fma_f32 v[28:29], v[26:27], v[26:27], v[28:29] op_sel:[1,1,0] op_sel_hi:[0,1,1] neg_lo:[1,0,0]
v_pk_mul_f32 v[30:31], v[28:29], v[28:29] op_sel_hi:[1,0]
v_pk_fma_f32 v[30:31], v[28:29], v[28:29], v[30:31] op_sel:[1,1,0] op_sel_hi:[0,1,1] neg_lo:[1,0,0]
v_xor_b32 v31, 0x80000000, v31
v_mov_b32 v53, 0x3f80
ds_write_addtid_b32 v53 offset:11808
v_cvt_pk_bf16_f32 v46, v30, v31
ds_write_addtid_b32 v46 offset:12096
v_pk_mul_f32 v[42:43], v[30:31], v[30:31] op_sel_hi:[1,0]
v_pk_fma_f32 v[42:43], v[30:31], v[30:31], v[42:43] op_sel:[1,1,0] op_sel_hi:[0,1,1] neg_lo:[1,0,0]
v_cvt_pk_bf16_f32 v47, v42, v43
ds_write_addtid_b32 v47 offset:12384
v_pk_mul_f32 v[44:45], v[42:43], v[30:31] op_sel_hi:[1,0]
v_pk_fma_f32 v[44:45], v[42:43], v[30:31], v[44:45] op_sel:[1,1,0] op_sel_hi:[0,1,1] neg_lo:[1,0,0]
v_cvt_pk_bf16_f32 v48, v44, v45
ds_write_addtid_b32 v48 offset:12672
v_pk_mul_f32 v[42:43], v[44:45], v[30:31] op_sel_hi:[1,0]
v_pk_fma_f32 v[42:43], v[44:45], v[30:31], v[42:43] op_sel:[1,1,0] op_sel_hi:[0,1,1] neg_lo:[1,0,0]
v_cvt_pk_bf16_f32 v49, v42, v43
ds_write_addtid_b32 v49 offset:12960
v_pk_mul_f32 v[44:45], v[42:43], v[30:31] op_sel_hi:[1,0]
v_pk_fma_f32 v[44:45], v[42:43], v[30:31], v[44:45] op_sel:[1,1,0] op_sel_hi:[0,1,1] neg_lo:[1,0,0]
v_cvt_pk_bf16_f32 v50, v44, v45
ds_write_addtid_b32 v50 offset:13248
v_pk_mul_f32 v[42:43], v[44:45], v[30:31] op_sel_hi:[1,0]
v_pk_fma_f32 v[42:43], v[44:45], v[30:31], v[42:43] op_sel:[1,1,0] op_sel_hi:[0,1,1] neg_lo:[1,0,0]
v_cvt_pk_bf16_f32 v51, v42, v43
ds_write_addtid_b32 v51 offset:13536
v_pk_mul_f32 v[44:45], v[42:43], v[30:31] op_sel_hi:[1,0]
v_pk_fma_f32 v[44:45], v[42:43], v[30:31], v[44:45] op_sel:[1,1,0] op_sel_hi:[0,1,1] neg_lo:[1,0,0]
v_cvt_pk_bf16_f32 v52, v44, v45
ds_write_addtid_b32 v52 offset:13824
v_pk_mul_f32 v[42:43], v[44:45], v[30:31] op_sel_hi:[1,0]
v_pk_fma_f32 v[42:43], v[44:45], v[30:31], v[42:43] op_sel:[1,1,0] op_sel_hi:[0,1,1] neg_lo:[1,0,0]
v_cvt_pk_bf16_f32 v46, v42, v43
ds_write_addtid_b32 v46 offset:14112
v_pk_mul_f32 v[44:45], v[42:43], v[30:31] op_sel_hi:[1,0]
v_pk_fma_f32 v[44:45], v[42:43], v[30:31], v[44:45] op_sel:[1,1,0] op_sel_hi:[0,1,1] neg_lo:[1,0,0]
v_cvt_pk_bf16_f32 v47, v44, v45
ds_write_addtid_b32 v47 offset:14400
v_pk_mul_f32 v[42:43], v[44:45], v[30:31] op_sel_hi:[1,0]
v_pk_fma_f32 v[42:43], v[44:45], v[30:31], v[42:43] op_sel:[1,1,0] op_sel_hi:[0,1,1] neg_lo:[1,0,0]
v_cvt_pk_bf16_f32 v48, v42, v43
ds_write_addtid_b32 v48 offset:14688
v_pk_mul_f32 v[44:45], v[42:43], v[30:31] op_sel_hi:[1,0]
v_pk_fma_f32 v[44:45], v[42:43], v[30:31], v[44:45] op_sel:[1,1,0] op_sel_hi:[0,1,1] neg_lo:[1,0,0]
v_cvt_pk_bf16_f32 v49, v44, v45
ds_write_addtid_b32 v49 offset:14976
v_pk_mul_f32 v[42:43], v[44:45], v[30:31] op_sel_hi:[1,0]
v_pk_fma_f32 v[42:43], v[44:45], v[30:31], v[42:43] op_sel:[1,1,0] op_sel_hi:[0,1,1] neg_lo:[1,0,0]
v_cvt_pk_bf16_f32 v50, v42, v43
ds_write_addtid_b32 v50 offset:15264
v_pk_mul_f32 v[44:45], v[42:43], v[30:31] op_sel_hi:[1,0]
v_pk_fma_f32 v[44:45], v[42:43], v[30:31], v[44:45] op_sel:[1,1,0] op_sel_hi:[0,1,1] neg_lo:[1,0,0]
v_cvt_pk_bf16_f32 v51, v44, v45
ds_write_addtid_b32 v51 offset:15552
v_pk_mul_f32 v[42:43], v[44:45], v[30:31] op_sel_hi:[1,0]
v_pk_fma_f32 v[42:43], v[44:45], v[30:31], v[42:43] op_sel:[1,1,0] op_sel_hi:[0,1,1] neg_lo:[1,0,0]
v_cvt_pk_bf16_f32 v52, v42, v43
ds_write_addtid_b32 v52 offset:15840
v_pk_mul_f32 v[44:45], v[42:43], v[30:31] op_sel_hi:[1,0]
v_pk_fma_f32 v[44:45], v[42:43], v[30:31], v[44:45] op_sel:[1,1,0] op_sel_hi:[0,1,1] neg_lo:[1,0,0]
v_cvt_pk_bf16_f32 v46, v44, v45
ds_write_addtid_b32 v46 offset:16128
ds_read_b128 v[112:115], v54 offset:11808
ds_read_b128 v[116:119], v54 offset:11872
ds_read_b128 v[120:123], v54 offset:11936
ds_read_b128 v[124:127], v54 offset:12000
v_cvt_pk_bf16_f32 v47, v34, v35
ds_write_addtid_b32 v47 offset:0
v_pk_mul_f32 v[38:39], v[34:35], v[24:25] op_sel_hi:[1,0]
v_pk_fma_f32 v[38:39], v[34:35], v[24:25], v[38:39] op_sel:[1,1,0] op_sel_hi:[0,1,1] neg_lo:[1,0,0]
v_cvt_pk_bf16_f32 v48, v38, v39
ds_write_addtid_b32 v48 offset:288
v_pk_mul_f32 v[40:41], v[38:39], v[24:25] op_sel_hi:[1,0]
v_pk_fma_f32 v[40:41], v[38:39], v[24:25], v[40:41] op_sel:[1,1,0] op_sel_hi:[0,1,1] neg_lo:[1,0,0]
v_cvt_pk_bf16_f32 v49, v40, v41
ds_write_addtid_b32 v49 offset:576
v_pk_mul_f32 v[38:39], v[40:41], v[24:25] op_sel_hi:[1,0]
v_pk_fma_f32 v[38:39], v[40:41], v[24:25], v[38:39] op_sel:[1,1,0] op_sel_hi:[0,1,1] neg_lo:[1,0,0]
v_cvt_pk_bf16_f32 v50, v38, v39
ds_write_addtid_b32 v50 offset:864
v_pk_mul_f32 v[40:41], v[38:39], v[24:25] op_sel_hi:[1,0]
v_pk_fma_f32 v[40:41], v[38:39], v[24:25], v[40:41] op_sel:[1,1,0] op_sel_hi:[0,1,1] neg_lo:[1,0,0]
v_cvt_pk_bf16_f32 v51, v40, v41
ds_write_addtid_b32 v51 offset:1152
v_pk_mul_f32 v[38:39], v[40:41], v[24:25] op_sel_hi:[1,0]
v_pk_fma_f32 v[38:39], v[40:41], v[24:25], v[38:39] op_sel:[1,1,0] op_sel_hi:[0,1,1] neg_lo:[1,0,0]
v_cvt_pk_bf16_f32 v52, v38, v39
ds_write_addtid_b32 v52 offset:1440
v_pk_mul_f32 v[40:41], v[38:39], v[24:25] op_sel_hi:[1,0]
v_pk_fma_f32 v[40:41], v[38:39], v[24:25], v[40:41] op_sel:[1,1,0] op_sel_hi:[0,1,1] neg_lo:[1,0,0]
v_cvt_pk_bf16_f32 v46, v40, v41
ds_write_addtid_b32 v46 offset:1728
v_pk_mul_f32 v[38:39], v[40:41], v[24:25] op_sel_hi:[1,0]
v_pk_fma_f32 v[38:39], v[40:41], v[24:25], v[38:39] op_sel:[1,1,0] op_sel_hi:[0,1,1] neg_lo:[1,0,0]
v_cvt_pk_bf16_f32 v47, v38, v39
ds_write_addtid_b32 v47 offset:2016
v_pk_mul_f32 v[36:37], v[34:35], v[32:33] op_sel_hi:[1,0]
v_pk_fma_f32 v[36:37], v[34:35], v[32:33], v[36:37] op_sel:[1,1,0] op_sel_hi:[0,1,1] neg_lo:[1,0,0]
v_cvt_pk_bf16_f32 v48, v36, v37
ds_write_addtid_b32 v48 offset:2304
v_pk_mul_f32 v[38:39], v[36:37], v[24:25] op_sel_hi:[1,0]
v_pk_fma_f32 v[38:39], v[36:37], v[24:25], v[38:39] op_sel:[1,1,0] op_sel_hi:[0,1,1] neg_lo:[1,0,0]
v_cvt_pk_bf16_f32 v49, v38, v39
ds_write_addtid_b32 v49 offset:2592
v_pk_mul_f32 v[40:41], v[38:39], v[24:25] op_sel_hi:[1,0]
v_pk_fma_f32 v[40:41], v[38:39], v[24:25], v[40:41] op_sel:[1,1,0] op_sel_hi:[0,1,1] neg_lo:[1,0,0]
v_cvt_pk_bf16_f32 v50, v40, v41
ds_write_addtid_b32 v50 offset:2880
v_pk_mul_f32 v[38:39], v[40:41], v[24:25] op_sel_hi:[1,0]
v_pk_fma_f32 v[38:39], v[40:41], v[24:25], v[38:39] op_sel:[1,1,0] op_sel_hi:[0,1,1] neg_lo:[1,0,0]
v_cvt_pk_bf16_f32 v51, v38, v39
ds_write_addtid_b32 v51 offset:3168
v_pk_mul_f32 v[40:41], v[38:39], v[24:25] op_sel_hi:[1,0]
v_pk_fma_f32 v[40:41], v[38:39], v[24:25], v[40:41] op_sel:[1,1,0] op_sel_hi:[0,1,1] neg_lo:[1,0,0]
v_cvt_pk_bf16_f32 v52, v40, v41
ds_write_addtid_b32 v52 offset:3456
v_pk_mul_f32 v[38:39], v[40:41], v[24:25] op_sel_hi:[1,0]
v_pk_fma_f32 v[38:39], v[40:41], v[24:25], v[38:39] op_sel:[1,1,0] op_sel_hi:[0,1,1] neg_lo:[1,0,0]
v_cvt_pk_bf16_f32 v46, v38, v39
ds_write_addtid_b32 v46 offset:3744
v_pk_mul_f32 v[40:41], v[38:39], v[24:25] op_sel_hi:[1,0]
v_pk_fma_f32 v[40:41], v[38:39], v[24:25], v[40:41] op_sel:[1,1,0] op_sel_hi:[0,1,1] neg_lo:[1,0,0]
v_cvt_pk_bf16_f32 v47, v40, v41
ds_write_addtid_b32 v47 offset:4032
v_pk_mul_f32 v[38:39], v[40:41], v[24:25] op_sel_hi:[1,0]
v_pk_fma_f32 v[38:39], v[40:41], v[24:25], v[38:39] op_sel:[1,1,0] op_sel_hi:[0,1,1] neg_lo:[1,0,0]
v_cvt_pk_bf16_f32 v48, v38, v39
ds_write_addtid_b32 v48 offset:4320
v_pk_mul_f32 v[34:35], v[36:37], v[32:33] op_sel_hi:[1,0]
v_pk_fma_f32 v[34:35], v[36:37], v[32:33], v[34:35] op_sel:[1,1,0] op_sel_hi:[0,1,1] neg_lo:[1,0,0]
ds_read_b128 v[64:67], v54 offset:0
ds_read_b128 v[68:71], v54 offset:64
ds_read_b128 v[72:75], v54 offset:128
ds_read_b128 v[76:79], v54 offset:192
v_cvt_pk_bf16_f32 v49, v34, v35
ds_write_addtid_b32 v49 offset:4608
v_pk_mul_f32 v[38:39], v[34:35], v[26:27] op_sel_hi:[1,0]
v_pk_fma_f32 v[38:39], v[34:35], v[26:27], v[38:39] op_sel:[1,1,0] op_sel_hi:[0,1,1] neg_lo:[1,0,0]
v_cvt_pk_bf16_f32 v50, v38, v39
ds_write_addtid_b32 v50 offset:4896
v_pk_mul_f32 v[40:41], v[38:39], v[26:27] op_sel_hi:[1,0]
v_pk_fma_f32 v[40:41], v[38:39], v[26:27], v[40:41] op_sel:[1,1,0] op_sel_hi:[0,1,1] neg_lo:[1,0,0]
v_cvt_pk_bf16_f32 v51, v40, v41
ds_write_addtid_b32 v51 offset:5184
v_pk_mul_f32 v[38:39], v[40:41], v[26:27] op_sel_hi:[1,0]
v_pk_fma_f32 v[38:39], v[40:41], v[26:27], v[38:39] op_sel:[1,1,0] op_sel_hi:[0,1,1] neg_lo:[1,0,0]
v_cvt_pk_bf16_f32 v52, v38, v39
ds_write_addtid_b32 v52 offset:5472
v_pk_mul_f32 v[36:37], v[34:35], v[32:33] op_sel_hi:[1,0]
v_pk_fma_f32 v[36:37], v[34:35], v[32:33], v[36:37] op_sel:[1,1,0] op_sel_hi:[0,1,1] neg_lo:[1,0,0]
v_cvt_pk_bf16_f32 v46, v36, v37
ds_write_addtid_b32 v46 offset:5760
v_pk_mul_f32 v[38:39], v[36:37], v[26:27] op_sel_hi:[1,0]
v_pk_fma_f32 v[38:39], v[36:37], v[26:27], v[38:39] op_sel:[1,1,0] op_sel_hi:[0,1,1] neg_lo:[1,0,0]
v_cvt_pk_bf16_f32 v47, v38, v39
ds_write_addtid_b32 v47 offset:6048
v_pk_mul_f32 v[40:41], v[38:39], v[26:27] op_sel_hi:[1,0]
v_pk_fma_f32 v[40:41], v[38:39], v[26:27], v[40:41] op_sel:[1,1,0] op_sel_hi:[0,1,1] neg_lo:[1,0,0]
v_cvt_pk_bf16_f32 v48, v40, v41
ds_write_addtid_b32 v48 offset:6336
v_pk_mul_f32 v[38:39], v[40:41], v[26:27] op_sel_hi:[1,0]
v_pk_fma_f32 v[38:39], v[40:41], v[26:27], v[38:39] op_sel:[1,1,0] op_sel_hi:[0,1,1] neg_lo:[1,0,0]
v_cvt_pk_bf16_f32 v49, v38, v39
ds_write_addtid_b32 v49 offset:6624
v_pk_mul_f32 v[34:35], v[36:37], v[32:33] op_sel_hi:[1,0]
v_pk_fma_f32 v[34:35], v[36:37], v[32:33], v[34:35] op_sel:[1,1,0] op_sel_hi:[0,1,1] neg_lo:[1,0,0]
s_waitcnt lgkmcnt(8)
.p2align 3
v_mfma_f32_16x16x32_bf16 v[128:131], v[64:67], v[112:115], 0
v_mfma_f32_16x16x32_bf16 v[128:131], v[68:71], v[116:119], v[128:131]
v_mfma_f32_16x16x32_bf16 v[128:131], v[72:75], v[120:123], v[128:131]
v_mfma_f32_16x16x32_bf16 v[128:131], v[76:79], v[124:127], v[128:131]
v_cvt_pk_bf16_f32 v50, v34, v35
ds_write_addtid_b32 v50 offset:6912
v_pk_mul_f32 v[38:39], v[34:35], v[28:29] op_sel_hi:[1,0]
v_pk_fma_f32 v[38:39], v[34:35], v[28:29], v[38:39] op_sel:[1,1,0] op_sel_hi:[0,1,1] neg_lo:[1,0,0]
v_cvt_pk_bf16_f32 v51, v38, v39
ds_write_addtid_b32 v51 offset:7200
v_pk_mul_f32 v[36:37], v[34:35], v[32:33] op_sel_hi:[1,0]
v_pk_fma_f32 v[36:37], v[34:35], v[32:33], v[36:37] op_sel:[1,1,0] op_sel_hi:[0,1,1] neg_lo:[1,0,0]
v_cvt_pk_bf16_f32 v52, v36, v37
ds_write_addtid_b32 v52 offset:7488
v_pk_mul_f32 v[38:39], v[36:37], v[28:29] op_sel_hi:[1,0]
v_pk_fma_f32 v[38:39], v[36:37], v[28:29], v[38:39] op_sel:[1,1,0] op_sel_hi:[0,1,1] neg_lo:[1,0,0]
v_cvt_pk_bf16_f32 v46, v38, v39
ds_write_addtid_b32 v46 offset:7776
v_pk_mul_f32 v[34:35], v[36:37], v[32:33] op_sel_hi:[1,0]
v_pk_fma_f32 v[34:35], v[36:37], v[32:33], v[34:35] op_sel:[1,1,0] op_sel_hi:[0,1,1] neg_lo:[1,0,0]
v_cvt_pk_bf16_f32 v47, v34, v35
ds_write_addtid_b32 v47 offset:8064
v_pk_mul_f32 v[38:39], v[34:35], v[28:29] op_sel_hi:[1,0]
v_pk_fma_f32 v[38:39], v[34:35], v[28:29], v[38:39] op_sel:[1,1,0] op_sel_hi:[0,1,1] neg_lo:[1,0,0]
v_cvt_pk_bf16_f32 v48, v38, v39
ds_write_addtid_b32 v48 offset:8352
v_pk_mul_f32 v[36:37], v[34:35], v[32:33] op_sel_hi:[1,0]
v_pk_fma_f32 v[36:37], v[34:35], v[32:33], v[36:37] op_sel:[1,1,0] op_sel_hi:[0,1,1] neg_lo:[1,0,0]
ds_write_b128 v8, v[128:131]
s_cmp_eq_u32 s63, 0
s_cbranch_scc1 LA_kf0
v_mov_b32 v150, 0
s_mov_b64 exec, 1
global_load_dwordx2 v[148:149], v150, s[38:39] offset:128 sc1
s_mov_b64 exec, -1
s_branch LA_kf
LA_kf0:
LA_kf:
.p2align 3
v_cvt_pk_bf16_f32 v49, v36, v37
ds_write_addtid_b32 v49 offset:8640
v_pk_mul_f32 v[38:39], v[36:37], v[28:29] op_sel_hi:[1,0]
v_pk_fma_f32 v[38:39], v[36:37], v[28:29], v[38:39] op_sel:[1,1,0] op_sel_hi:[0,1,1] neg_lo:[1,0,0]
v_cvt_pk_bf16_f32 v50, v38, v39
ds_write_addtid_b32 v50 offset:8928
v_pk_mul_f32 v[34:35], v[36:37], v[32:33] op_sel_hi:[1,0]
v_pk_fma_f32 v[34:35], v[36:37], v[32:33], v[34:35] op_sel:[1,1,0] op_sel_hi:[0,1,1] neg_lo:[1,0,0]
ds_read_b128 v[80:83], v54 offset:4608
ds_read_b128 v[84:87], v54 offset:4672
ds_read_b128 v[88:91], v54 offset:4736
ds_read_b128 v[92:95], v54 offset:4800
v_cvt_pk_bf16_f32 v51, v34, v35
ds_write_addtid_b32 v51 offset:9216
v_pk_mul_f32 v[36:37], v[34:35], v[32:33] op_sel_hi:[1,0]
v_pk_fma_f32 v[36:37], v[34:35], v[32:33], v[36:37] op_sel:[1,1,0] op_sel_hi:[0,1,1] neg_lo:[1,0,0]
v_cvt_pk_bf16_f32 v52, v36, v37
ds_write_addtid_b32 v52 offset:9504
v_pk_mul_f32 v[34:35], v[36:37], v[32:33] op_sel_hi:[1,0]
v_pk_fma_f32 v[34:35], v[36:37], v[32:33], v[34:35] op_sel:[1,1,0] op_sel_hi:[0,1,1] neg_lo:[1,0,0]
v_cvt_pk_bf16_f32 v46, v34, v35
ds_write_addtid_b32 v46 offset:9792
v_pk_mul_f32 v[36:37], v[34:35], v[32:33] op_sel_hi:[1,0]
v_pk_fma_f32 v[36:37], v[34:35], v[32:33], v[36:37] op_sel:[1,1,0] op_sel_hi:[0,1,1] neg_lo:[1,0,0]
v_cvt_pk_bf16_f32 v47, v36, v37
ds_write_addtid_b32 v47 offset:10080
v_pk_mul_f32 v[34:35], v[36:37], v[32:33] op_sel_hi:[1,0]
v_pk_fma_f32 v[34:35], v[36:37], v[32:33], v[34:35] op_sel:[1,1,0] op_sel_hi:[0,1,1] neg_lo:[1,0,0]
v_cvt_pk_bf16_f32 v48, v34, v35
ds_write_addtid_b32 v48 offset:10368
v_pk_mul_f32 v[36:37], v[34:35], v[32:33] op_sel_hi:[1,0]
v_pk_fma_f32 v[36:37], v[34:35], v[32:33], v[36:37] op_sel:[1,1,0] op_sel_hi:[0,1,1] neg_lo:[1,0,0]
s_waitcnt lgkmcnt(5)
.p2align 3
v_mfma_f32_16x16x32_bf16 v[132:135], v[80:83], v[112:115], 0
v_mfma_f32_16x16x32_bf16 v[132:135], v[84:87], v[116:119], v[132:135]
v_mfma_f32_16x16x32_bf16 v[132:135], v[88:91], v[120:123], v[132:135]
v_mfma_f32_16x16x32_bf16 v[132:135], v[92:95], v[124:127], v[132:135]
v_cvt_pk_bf16_f32 v49, v36, v37
ds_write_addtid_b32 v49 offset:10656
v_pk_mul_f32 v[34:35], v[36:37], v[32:33] op_sel_hi:[1,0]
v_pk_fma_f32 v[34:35], v[36:37], v[32:33], v[34:35] op_sel:[1,1,0] op_sel_hi:[0,1,1] neg_lo:[1,0,0]
v_cvt_pk_bf16_f32 v50, v34, v35
ds_write_addtid_b32 v50 offset:10944
v_pk_mul_f32 v[36:37], v[34:35], v[32:33] op_sel_hi:[1,0]
v_pk_fma_f32 v[36:37], v[34:35], v[32:33], v[36:37] op_sel:[1,1,0] op_sel_hi:[0,1,1] neg_lo:[1,0,0]
v_cvt_pk_bf16_f32 v51, v36, v37
ds_write_addtid_b32 v51 offset:11232
v_pk_mul_f32 v[34:35], v[36:37], v[32:33] op_sel_hi:[1,0]
v_pk_fma_f32 v[34:35], v[36:37], v[32:33], v[34:35] op_sel:[1,1,0] op_sel_hi:[0,1,1] neg_lo:[1,0,0]
v_cvt_pk_bf16_f32 v52, v34, v35
ds_write_addtid_b32 v52 offset:11520
ds_read_b128 v[96:99], v54 offset:9216
ds_read_b128 v[100:103], v54 offset:9280
ds_read_b128 v[104:107], v54 offset:9344
ds_read_b128 v[108:111], v54 offset:9408
ds_write_b64 v9, v[132:133] offset:1024
ds_write_b64 v10, v[134:135] offset:1024
s_waitcnt lgkmcnt(2)
.p2align 3
v_mfma_f32_16x16x32_bf16 v[136:139], v[96:99], v[112:115], 0
v_mfma_f32_16x16x32_bf16 v[136:139], v[100:103], v[116:119], v[136:139]
v_mfma_f32_16x16x32_bf16 v[136:139], v[104:107], v[120:123], v[136:139]
v_mfma_f32_16x16x32_bf16 v[136:139], v[108:111], v[124:127], v[136:139]
s_nop 7
ds_write2_b32 v11, v136, v137 offset0:0 offset1:16
ds_write2_b32 v11, v138, v139 offset0:32 offset1:48
s_cmp_eq_u32 s63, 0
s_cbranch_scc1 LA_k2
s_waitcnt vmcnt(0)
s_mov_b32 s67, 0
Lpl8:
v_readfirstlane_b32 s68, v148
v_readfirstlane_b32 s69, v149
s_add_u32 s67, s67, 1
s_cmp_lg_u32 s68, 0
s_cbranch_scc1 Lpe8
s_sleep 8
v_mov_b32 v150, 0
s_mov_b64 exec, 1
global_load_dwordx2 v[148:149], v150, s[38:39] offset:128 sc1
s_mov_b64 exec, -1
s_waitcnt vmcnt(0)
s_cmp_lt_u32 s67, 0x40000
s_cbranch_scc1 Lpl8
Lpe8:
s_cmp_eq_u32 s60, 1
s_cbranch_scc1 LA_k45
s_cmp_lg_u32 s60, 2
s_cbranch_scc1 LA_kb
s_waitcnt vmcnt(0)
s_lshl_b32 s50, s44, 2
v_mov_b32 v150, s50
v_mov_b32 v151, 1
s_mov_b64 exec, 1
global_store_dword v150, v151, s[38:39] sc0 sc1
s_mov_b64 exec, -1
s_branch LA_kb
LA_k45:
s_call_b64 s[64:65], LT_fin
s_waitcnt vmcnt(0)
s_call_b64 s[64:65], LT_signal
s_cmp_lg_u32 s3, 4
s_cbranch_scc1 LA_kb
v_mov_b32 v148, 0
s_mov_b32 s67, 0
s_branch Lpc9
Lpl9:
global_load_dwordx2 v[148:149], v15, s[40:41] sc1
s_waitcnt vmcnt(0)
Lpc9:
v_cmp_ne_u64 vcc, s[68:69], v[148:149]
s_add_u32 s67, s67, 1
s_nop 3
s_cbranch_vccz Lpe9
s_sleep 8
s_cmp_lt_u32 s67, 0x40000
s_cbranch_scc1 Lpl9
Lpe9:
s_branch LA_kb
LA_k2:
s_waitcnt vmcnt(0)
ds_write_b128 v12, v[140:143] offset:128
ds_write_b128 v12, v[144:147] offset:9600
LA_kb:
s_waitcnt lgkmcnt(0)
s_barrier
s_cmp_eq_u32 s63, 0
s_cbranch_scc1 LA_nl
buffer_load_dwordx4 v[140:143], v55, s[12:15], s56 offen sc1
buffer_load_dwordx4 v[144:147], v55, s[12:15], s57 offen sc1
LA_nl:
s_cmp_ge_u32 s3, 4
s_cbranch_scc1 LA_help
v_add_u32 v72, 65664, v3
v_add_u32 v73, 65664, v2
ds_read_b64 v[40:41], v3 offset:2048
ds_read_b32 v42, v3 offset:2056
ds_read_b64 v[44:45], v72 offset:2048
ds_read_b32 v46, v72 offset:2056
ds_read_b64 v[32:33], v3 offset:1536
ds_read_b32 v34, v3 offset:1544
ds_read_b64 v[36:37], v72 offset:1536
ds_read_b32 v38, v72 offset:1544
ds_read_b64 v[24:25], v3 offset:1024
ds_read_b32 v26, v3 offset:1032
ds_read_b64 v[28:29], v72 offset:1024
ds_read_b32 v30, v72 offset:1032
ds_read_b128 v[64:67], v2
ds_read_b128 v[68:71], v73
ds_write_b32 v13, v14 offset:4096
v_cndmask_b32 v21, 0, v21, s[58:59]
s_waitcnt lgkmcnt(11)
v_add_f32 v40, v40, v44
v_add_f32 v41, v41, v45
v_add_f32 v42, v42, v46
v_cvt_pk_bf16_f32 v56, v40, v40
v_cvt_pk_bf16_f32 v57, v40, v40
v_cvt_pk_bf16_f32 v58, v40, v41
v_cvt_pk_bf16_f32 v59, v41, v41
ds_write_b128 v7, v[56:59] offset:6176
v_cvt_pk_bf16_f32 v60, v41, v41
v_cvt_pk_bf16_f32 v61, v41, v41
v_cvt_pk_bf16_f32 v62, v42, v42
v_cvt_pk_bf16_f32 v63, v42, v42
ds_write_b128 v7, v[60:63] offset:6192
s_waitcnt lgkmcnt(9)
v_add_f32 v32, v32, v36
v_add_f32 v33, v33, v37
v_add_f32 v34, v34, v38
v_cvt_pk_bf16_f32 v52, v32, v32
v_cvt_pk_bf16_f32 v53, v32, v33
v_cvt_pk_bf16_f32 v54, v33, v33
v_cvt_pk_bf16_f32 v55, v34, v34
ds_write_b128 v2, v[52:55] offset:5152
s_waitcnt lgkmcnt(6)
v_add_f32 v24, v24, v28
v_add_f32 v25, v25, v29
v_add_f32 v26, v26, v30
v_cvt_pk_bf16_f32 v48, v24, v24
v_cvt_pk_bf16_f32 v49, v25, v26
ds_write_b64 v3, v[48:49] offset:4640
s_waitcnt lgkmcnt(5)
v_add_f32 v64, v64, v21
v_add_f32 v64, v64, v68
v_add_f32 v65, v65, v69
v_add_f32 v66, v66, v70
v_add_f32 v67, v67, v71
v_cvt_pk_bf16_f32 v68, v64, v65
v_cvt_pk_bf16_f32 v69, v66, v67
ds_write_b64 v3, v[68:69] offset:4128
v_mov_b32 v164, 0
v_mov_b32 v165, 0
v_mov_b32 v170, 0
v_mov_b32 v171, 0
v_mov_b32 v176, 0
v_mov_b32 v177, 0
v_mov_b32 v182, 0
v_mov_b32 v183, 0
v_mov_b32 v188, 0
v_mov_b32 v189, 0
v_mov_b32 v194, 0
v_mov_b32 v195, 0
v_mov_b32 v200, 0
v_mov_b32 v201, 0
v_mov_b32 v206, 0
v_mov_b32 v207, 0
v_mov_b32 v212, 0
v_mov_b32 v213, 0
v_mov_b32 v218, 0
v_mov_b32 v219, 0
v_mov_b32 v224, 0
v_mov_b32 v225, 0
v_mov_b32 v230, 0
v_mov_b32 v231, 0
v_mov_b32 v236, 0
v_mov_b32 v237, 0
v_mov_b32 v242, 0
v_mov_b32 v243, 0
v_mov_b32 v248, 0
v_mov_b32 v249, 0
v_mov_b32 v254, 0
v_mov_b32 v255, 0
s_cmp_eq_u32 s63, 0
s_cbranch_scc1 LA_c0
s_waitcnt vmcnt(0)
ds_write_b128 v12, v[140:143] offset:128
ds_write_b128 v12, v[144:147] offset:9600
s_waitcnt lgkmcnt(0)
s_barrier
LA_c0:
ds_read_b64 v[16:17], v5 offset:8
ds_read_b64 v[18:19], v5 offset:16
ds_read_b64_tr_b16 v[156:157], v4 offset:7968
ds_read_b64_tr_b16 v[158:159], v4 offset:7936
ds_read_b64_tr_b16 v[148:149], v4 offset:7456
ds_read_b64_tr_b16 v[150:151], v4 offset:7424
ds_read_b64_tr_b16 v[140:141], v4 offset:6944
ds_read_b64_tr_b16 v[142:143], v4 offset:6912
ds_read_b64_tr_b16 v[132:133], v4 offset:6432
ds_read_b64_tr_b16 v[134:135], v4 offset:6400
ds_read_b64_tr_b16 v[124:125], v4 offset:5920
ds_read_b64_tr_b16 v[126:127], v4 offset:5888
ds_read_b64_tr_b16 v[116:117], v4 offset:5408
ds_read_b64_tr_b16 v[118:119], v4 offset:5376
ds_read_b64_tr_b16 v[108:109], v4 offset:4896
ds_read_b64_tr_b16 v[110:111], v4 offset:4864
ds_read_b64_tr_b16 v[100:101], v4 offset:4384
ds_read_b64_tr_b16 v[102:103], v4 offset:4352
ds_read_b64 v[20:21], v5 offset:1192
ds_read_b64 v[22:23], v5 offset:1200
s_waitcnt lgkmcnt(15)
v_mfma_f32_16x16x32_bf16 v[244:247], v[156:159], v[16:19], 0
ds_read_b64 v[24:25], v5 offset:2376
s_waitcnt lgkmcnt(15)
v_mfma_f32_16x16x32_bf16 v[232:235], v[148:151], v[16:19], 0
ds_read_b64 v[26:27], v5 offset:2384
s_waitcnt lgkmcnt(14)
v_mfma_f32_16x16x32_bf16 v[220:223], v[140:143], v[16:19], 0
ds_read_b64 v[28:29], v5 offset:3560
s_waitcnt lgkmcnt(13)
v_mfma_f32_16x16x32_bf16 v[208:211], v[132:135], v[16:19], 0
ds_read_b64 v[30:31], v5 offset:3568
s_waitcnt lgkmcnt(12)
v_mfma_f32_16x16x32_bf16 v[196:199], v[124:127], v[16:19], 0
ds_read_b64_tr_b16 v[152:153], v4 offset:7712
s_waitcnt lgkmcnt(11)
v_mfma_f32_16x16x32_bf16 v[184:187], v[116:119], v[16:19], 0
ds_read_b64_tr_b16 v[154:155], v4 offset:7680
s_waitcnt lgkmcnt(10)
v_mfma_f32_16x16x32_bf16 v[172:175], v[108:111], v[16:19], 0
ds_read_b64_tr_b16 v[144:145], v4 offset:7200
s_waitcnt lgkmcnt(9)
v_mfma_f32_16x16x32_bf16 v[160:163], v[100:103], v[16:19], 0
ds_read_b64_tr_b16 v[146:147], v4 offset:7168
s_waitcnt lgkmcnt(8)
v_mfma_f32_16x16x32_bf16 v[250:253], v[156:159], v[20:23], 0
ds_read_b64_tr_b16 v[136:137], v4 offset:6688
v_mfma_f32_16x16x32_bf16 v[238:241], v[148:151], v[20:23], 0
ds_read_b64_tr_b16 v[138:139], v4 offset:6656
v_mfma_f32_16x16x32_bf16 v[226:229], v[140:143], v[20:23], 0
ds_read_b64_tr_b16 v[128:129], v4 offset:6176
v_mfma_f32_16x16x32_bf16 v[214:217], v[132:135], v[20:23], 0
ds_read_b64_tr_b16 v[130:131], v4 offset:6144
v_mfma_f32_16x16x32_bf16 v[202:205], v[124:127], v[20:23], 0
ds_read_b64_tr_b16 v[120:121], v4 offset:5664
v_mfma_f32_16x16x32_bf16 v[190:193], v[116:119], v[20:23], 0
ds_read_b64_tr_b16 v[122:123], v4 offset:5632
v_mfma_f32_16x16x32_bf16 v[178:181], v[108:111], v[20:23], 0
ds_read_b64_tr_b16 v[112:113], v4 offset:5152
v_mfma_f32_16x16x32_bf16 v[166:169], v[100:103], v[20:23], 0
ds_read_b64_tr_b16 v[114:115], v4 offset:5120
s_waitcnt lgkmcnt(14)
v_mfma_f32_16x16x32_bf16 v[246:249], v[156:159], v[24:27], v[246:249]
ds_read_b64_tr_b16 v[104:105], v4 offset:4640
v_mfma_f32_16x16x32_bf16 v[234:237], v[148:151], v[24:27], v[234:237]
ds_read_b64_tr_b16 v[106:107], v4 offset:4608
v_mfma_f32_16x16x32_bf16 v[222:225], v[140:143], v[24:27], v[222:225]
ds_read_b64_tr_b16 v[96:97], v4 offset:4128
v_mfma_f32_16x16x32_bf16 v[210:213], v[132:135], v[24:27], v[210:213]
ds_read_b64_tr_b16 v[98:99], v4 offset:4096
v_mfma_f32_16x16x32_bf16 v[198:201], v[124:127], v[24:27], v[198:201]
ds_write_b32 v13, v14 offset:0
v_mfma_f32_16x16x32_bf16 v[186:189], v[116:119], v[24:27], v[186:189]
ds_read_b64 v[32:33], v5 offset:72
v_mfma_f32_16x16x32_bf16 v[174:177], v[108:111], v[24:27], v[174:177]
ds_read_b64 v[34:35], v5 offset:80
v_mfma_f32_16x16x32_bf16 v[162:165], v[100:103], v[24:27], v[162:165]
ds_read_b64 v[36:37], v5 offset:1256
s_waitcnt lgkmcnt(15)
v_mfma_f32_16x16x32_bf16 v[252:255], v[156:159], v[28:31], v[252:255]
ds_read_b64 v[38:39], v5 offset:1264
v_mfma_f32_16x16x32_bf16 v[240:243], v[148:151], v[28:31], v[240:243]
ds_read_b64 v[40:41], v5 offset:2440
v_mfma_f32_16x16x32_bf16 v[228:231], v[140:143], v[28:31], v[228:231]
ds_read_b64 v[42:43], v5 offset:2448
v_mfma_f32_16x16x32_bf16 v[216:219], v[132:135], v[28:31], v[216:219]
ds_read_b64 v[44:45], v5 offset:3624
v_mfma_f32_16x16x32_bf16 v[204:207], v[124:127], v[28:31], v[204:207]
ds_read_b64 v[46:47], v5 offset:3632
v_mfma_f32_16x16x32_bf16 v[192:195], v[116:119], v[28:31], v[192:195]
ds_read_b64 v[48:49], v5 offset:136
v_mfma_f32_16x16x32_bf16 v[180:183], v[108:111], v[28:31], v[180:183]
ds_read_b64 v[50:51], v5 offset:144
v_mfma_f32_16x16x32_bf16 v[168:171], v[100:103], v[28:31], v[168:171]
ds_read_b64 v[52:53], v5 offset:1320
s_waitcnt lgkmcnt(9)
v_mfma_f32_16x16x32_bf16 v[244:247], v[152:155], v[32:35], v[244:247]
ds_read_b64 v[54:55], v5 offset:1328
v_mfma_f32_16x16x32_bf16 v[232:235], v[144:147], v[32:35], v[232:235]
ds_read_b64 v[56:57], v5 offset:2504
v_mfma_f32_16x16x32_bf16 v[220:223], v[136:139], v[32:35], v[220:223]
ds_read_b64 v[58:59], v5 offset:2512
v_mfma_f32_16x16x32_bf16 v[208:211], v[128:131], v[32:35], v[208:211]
ds_read_b64 v[60:61], v5 offset:3688
v_mfma_f32_16x16x32_bf16 v[196:199], v[120:123], v[32:35], v[196:199]
ds_read_b64 v[62:63], v5 offset:3696
v_mfma_f32_16x16x32_bf16 v[184:187], v[112:115], v[32:35], v[184:187]
ds_read_b64 v[64:65], v5 offset:200
v_mfma_f32_16x16x32_bf16 v[172:175], v[104:107], v[32:35], v[172:175]
ds_read_b64 v[66:67], v5 offset:208
v_mfma_f32_16x16x32_bf16 v[160:163], v[96:99], v[32:35], v[160:163]
ds_read_b64 v[68:69], v5 offset:1384
s_waitcnt lgkmcnt(15)
v_mfma_f32_16x16x32_bf16 v[250:253], v[152:155], v[36:39], v[250:253]
ds_read_b64 v[70:71], v5 offset:1392
v_mfma_f32_16x16x32_bf16 v[238:241], v[144:147], v[36:39], v[238:241]
ds_read_b64 v[72:73], v5 offset:2568
v_mfma_f32_16x16x32_bf16 v[226:229], v[136:139], v[36:39], v[226:229]
ds_read_b64 v[74:75], v5 offset:2576
v_mfma_f32_16x16x32_bf16 v[214:217], v[128:131], v[36:39], v[214:217]
ds_read_b64 v[76:77], v5 offset:3752
v_mfma_f32_16x16x32_bf16 v[202:205], v[120:123], v[36:39], v[202:205]
ds_read_b64 v[78:79], v5 offset:3760
v_mfma_f32_16x16x32_bf16 v[190:193], v[112:115], v[36:39], v[190:193]
ds_read_b64 v[80:81], v5 offset:264
v_mfma_f32_16x16x32_bf16 v[178:181], v[104:107], v[36:39], v[178:181]
ds_read_b64 v[82:83], v5 offset:272
v_mfma_f32_16x16x32_bf16 v[166:169], v[96:99], v[36:39], v[166:169]
ds_read_b64 v[84:85], v5 offset:1448
s_waitcnt lgkmcnt(15)
v_mfma_f32_16x16x32_bf16 v[246:249], v[152:155], v[40:43], v[246:249]
ds_read_b64 v[86:87], v5 offset:1456
v_mfma_f32_16x16x32_bf16 v[234:237], v[144:147], v[40:43], v[234:237]
ds_read_b64 v[88:89], v5 offset:2632
v_mfma_f32_16x16x32_bf16 v[222:225], v[136:139], v[40:43], v[222:225]
ds_read_b64 v[90:91], v5 offset:2640
v_mfma_f32_16x16x32_bf16 v[210:213], v[128:131], v[40:43], v[210:213]
ds_read_b64 v[92:93], v5 offset:3816
v_mfma_f32_16x16x32_bf16 v[198:201], v[120:123], v[40:43], v[198:201]
ds_read_b64 v[94:95], v5 offset:3824
v_mfma_f32_16x16x32_bf16 v[186:189], v[112:115], v[40:43], v[186:189]
ds_read_b64 v[16:17], v5 offset:328
v_mfma_f32_16x16x32_bf16 v[174:177], v[104:107], v[40:43], v[174:177]
ds_read_b64 v[18:19], v5 offset:336
v_mfma_f32_16x16x32_bf16 v[162:165], v[96:99], v[40:43], v[162:165]
ds_read_b64 v[20:21], v5 offset:1512
v_mfma_f32_16x16x32_bf16 v[252:255], v[152:155], v[44:47], v[252:255]
ds_read_b64 v[22:23], v5 offset:1520
v_mfma_f32_16x16x32_bf16 v[240:243], v[144:147], v[44:47], v[240:243]
ds_read_b64 v[24:25], v5 offset:2696
v_mfma_f32_16x16x32_bf16 v[228:231], v[136:139], v[44:47], v[228:231]
ds_read_b64 v[26:27], v5 offset:2704
v_mfma_f32_16x16x32_bf16 v[216:219], v[128:131], v[44:47], v[216:219]
ds_read_b64 v[28:29], v5 offset:3880
v_mfma_f32_16x16x32_bf16 v[204:207], v[120:123], v[44:47], v[204:207]
ds_read_b64 v[30:31], v5 offset:3888
v_mfma_f32_16x16x32_bf16 v[192:195], v[112:115], v[44:47], v[192:195]
ds_read_b64 v[32:33], v5 offset:392
v_mfma_f32_16x16x32_bf16 v[180:183], v[104:107], v[44:47], v[180:183]
ds_read_b64 v[34:35], v5 offset:400
v_mfma_f32_16x16x32_bf16 v[168:171], v[96:99], v[44:47], v[168:171]
ds_read_b64 v[36:37], v5 offset:1576
v_mfma_f32_16x16x32_bf16 v[172:175], v[100:103], v[48:51], v[172:175]
ds_read_b64 v[38:39], v5 offset:1584
v_mfma_f32_16x16x32_bf16 v[184:187], v[108:111], v[48:51], v[184:187]
ds_read_b64 v[40:41], v5 offset:2760
v_mfma_f32_16x16x32_bf16 v[196:199], v[116:119], v[48:51], v[196:199]
ds_read_b64 v[42:43], v5 offset:2768
v_mfma_f32_16x16x32_bf16 v[208:211], v[124:127], v[48:51], v[208:211]
v_mfma_f32_16x16x32_bf16 v[220:223], v[132:135], v[48:51], v[220:223]
v_mfma_f32_16x16x32_bf16 v[232:235], v[140:143], v[48:51], v[232:235]
v_mfma_f32_16x16x32_bf16 v[244:247], v[148:151], v[48:51], v[244:247]
v_mfma_f32_16x16x32_bf16 v[178:181], v[100:103], v[52:55], v[178:181]
ds_read_b64 v[44:45], v5 offset:3944
v_mfma_f32_16x16x32_bf16 v[190:193], v[108:111], v[52:55], v[190:193]
v_add_f32 v161, v161, v166
v_add_f32 v162, v162, v167
v_mfma_f32_16x16x32_bf16 v[202:205], v[116:119], v[52:55], v[202:205]
v_add_f32 v163, v163, v168
v_add_f32 v169, v169, v164
v_mfma_f32_16x16x32_bf16 v[214:217], v[124:127], v[52:55], v[214:217]
ds_write_b128 v2, v[160:163] offset:8448
v_mfma_f32_16x16x32_bf16 v[226:229], v[132:135], v[52:55], v[226:229]
v_add_f32 v170, v170, v165
v_mov_b32 v168, 0
v_mfma_f32_16x16x32_bf16 v[238:241], v[140:143], v[52:55], v[238:241]
ds_write_b128 v6, v[168:171] offset:0
v_mfma_f32_16x16x32_bf16 v[250:253], v[148:151], v[52:55], v[250:253]
ds_read_b64 v[46:47], v5 offset:3952
s_waitcnt lgkmcnt(15)
v_mfma_f32_16x16x32_bf16 v[174:177], v[100:103], v[56:59], v[174:177]
ds_read_b64 v[48:49], v5 offset:456
v_mfma_f32_16x16x32_bf16 v[186:189], v[108:111], v[56:59], v[186:189]
ds_read_b64 v[50:51], v5 offset:464
v_mfma_f32_16x16x32_bf16 v[198:201], v[116:119], v[56:59], v[198:201]
v_mfma_f32_16x16x32_bf16 v[210:213], v[124:127], v[56:59], v[210:213]
v_mfma_f32_16x16x32_bf16 v[222:225], v[132:135], v[56:59], v[222:225]
s_waitcnt lgkmcnt(3)
s_barrier
v_mfma_f32_16x16x32_bf16 v[234:237], v[140:143], v[56:59], v[234:237]
v_mfma_f32_16x16x32_bf16 v[246:249], v[148:151], v[56:59], v[246:249]
v_mfma_f32_16x16x32_bf16 v[180:183], v[100:103], v[60:63], v[180:183]
ds_read_b64 v[52:53], v5 offset:1640
v_mfma_f32_16x16x32_bf16 v[192:195], v[108:111], v[60:63], v[192:195]
ds_read_b64 v[54:55], v5 offset:1648
v_mfma_f32_16x16x32_bf16 v[204:207], v[116:119], v[60:63], v[204:207]
v_mfma_f32_16x16x32_bf16 v[216:219], v[124:127], v[60:63], v[216:219]
v_mfma_f32_16x16x32_bf16 v[228:231], v[132:135], v[60:63], v[228:231]
v_mfma_f32_16x16x32_bf16 v[240:243], v[140:143], v[60:63], v[240:243]
v_mfma_f32_16x16x32_bf16 v[252:255], v[148:151], v[60:63], v[252:255]
v_mfma_f32_16x16x32_bf16 v[172:175], v[96:99], v[64:67], v[172:175]
ds_read_b64 v[56:57], v5 offset:2824
v_mfma_f32_16x16x32_bf16 v[184:187], v[104:107], v[64:67], v[184:187]
ds_read_b64 v[58:59], v5 offset:2832
v_mfma_f32_16x16x32_bf16 v[196:199], v[112:115], v[64:67], v[196:199]
v_mfma_f32_16x16x32_bf16 v[208:211], v[120:123], v[64:67], v[208:211]
v_mfma_f32_16x16x32_bf16 v[220:223], v[128:131], v[64:67], v[220:223]
v_mfma_f32_16x16x32_bf16 v[232:235], v[136:139], v[64:67], v[232:235]
v_mfma_f32_16x16x32_bf16 v[244:247], v[144:147], v[64:67], v[244:247]
v_mfma_f32_16x16x32_bf16 v[178:181], v[96:99], v[68:71], v[178:181]
ds_read_b64 v[60:61], v5 offset:4008
v_mfma_f32_16x16x32_bf16 v[190:193], v[104:107], v[68:71], v[190:193]
ds_read_b64 v[62:63], v5 offset:4016
v_mfma_f32_16x16x32_bf16 v[202:205], v[112:115], v[68:71], v[202:205]
v_mfma_f32_16x16x32_bf16 v[214:217], v[120:123], v[68:71], v[214:217]
v_mfma_f32_16x16x32_bf16 v[226:229], v[128:131], v[68:71], v[226:229]
v_mfma_f32_16x16x32_bf16 v[238:241], v[136:139], v[68:71], v[238:241]
v_mfma_f32_16x16x32_bf16 v[250:253], v[144:147], v[68:71], v[250:253]
v_mfma_f32_16x16x32_bf16 v[174:177], v[96:99], v[72:75], v[174:177]
ds_read_b64 v[64:65], v5 offset:520
v_mfma_f32_16x16x32_bf16 v[186:189], v[104:107], v[72:75], v[186:189]
ds_read_b64 v[66:67], v5 offset:528
v_mfma_f32_16x16x32_bf16 v[198:201], v[112:115], v[72:75], v[198:201]
v_mfma_f32_16x16x32_bf16 v[210:213], v[120:123], v[72:75], v[210:213]
v_mfma_f32_16x16x32_bf16 v[222:225], v[128:131], v[72:75], v[222:225]
v_mfma_f32_16x16x32_bf16 v[234:237], v[136:139], v[72:75], v[234:237]
v_mfma_f32_16x16x32_bf16 v[246:249], v[144:147], v[72:75], v[246:249]
v_mfma_f32_16x16x32_bf16 v[180:183], v[96:99], v[76:79], v[180:183]
ds_read_b64 v[68:69], v5 offset:1704
v_mfma_f32_16x16x32_bf16 v[192:195], v[104:107], v[76:79], v[192:195]
ds_read_b64 v[70:71], v5 offset:1712
v_mfma_f32_16x16x32_bf16 v[204:207], v[112:115], v[76:79], v[204:207]
v_mfma_f32_16x16x32_bf16 v[216:219], v[120:123], v[76:79], v[216:219]
v_mfma_f32_16x16x32_bf16 v[228:231], v[128:131], v[76:79], v[228:231]
v_mfma_f32_16x16x32_bf16 v[240:243], v[136:139], v[76:79], v[240:243]
v_mfma_f32_16x16x32_bf16 v[252:255], v[144:147], v[76:79], v[252:255]
v_mfma_f32_16x16x32_bf16 v[184:187], v[100:103], v[80:83], v[184:187]
v_add_f32 v173, v173, v178
v_add_f32 v174, v174, v179
v_mfma_f32_16x16x32_bf16 v[196:199], v[108:111], v[80:83], v[196:199]
v_add_f32 v175, v175, v180
v_add_f32 v181, v181, v176
v_mfma_f32_16x16x32_bf16 v[208:211], v[116:119], v[80:83], v[208:211]
ds_write_b128 v2, v[172:175] offset:9472
v_mfma_f32_16x16x32_bf16 v[220:223], v[124:127], v[80:83], v[220:223]
v_add_f32 v182, v182, v177
v_mov_b32 v180, 0
v_mfma_f32_16x16x32_bf16 v[232:235], v[132:135], v[80:83], v[232:235]
ds_write_b128 v6, v[180:183] offset:1024
v_mfma_f32_16x16x32_bf16 v[244:247], v[140:143], v[80:83], v[244:247]
ds_read_b64 v[72:73], v5 offset:2888
v_mfma_f32_16x16x32_bf16 v[190:193], v[100:103], v[84:87], v[190:193]
ds_read_b64 v[74:75], v5 offset:2896
v_mfma_f32_16x16x32_bf16 v[202:205], v[108:111], v[84:87], v[202:205]
ds_read_b64 v[76:77], v5 offset:4072
v_mfma_f32_16x16x32_bf16 v[214:217], v[116:119], v[84:87], v[214:217]
ds_read_b64 v[78:79], v5 offset:4080
v_mfma_f32_16x16x32_bf16 v[226:229], v[124:127], v[84:87], v[226:229]
v_mfma_f32_16x16x32_bf16 v[238:241], v[132:135], v[84:87], v[238:241]
s_waitcnt lgkmcnt(4)
s_barrier
v_mfma_f32_16x16x32_bf16 v[250:253], v[140:143], v[84:87], v[250:253]
v_mfma_f32_16x16x32_bf16 v[186:189], v[100:103], v[88:91], v[186:189]
ds_read_b64 v[80:81], v5 offset:584
v_mfma_f32_16x16x32_bf16 v[198:201], v[108:111], v[88:91], v[198:201]
ds_read_b64 v[82:83], v5 offset:592
v_mfma_f32_16x16x32_bf16 v[210:213], v[116:119], v[88:91], v[210:213]
v_mfma_f32_16x16x32_bf16 v[222:225], v[124:127], v[88:91], v[222:225]
v_mfma_f32_16x16x32_bf16 v[234:237], v[132:135], v[88:91], v[234:237]
v_mfma_f32_16x16x32_bf16 v[246:249], v[140:143], v[88:91], v[246:249]
v_mfma_f32_16x16x32_bf16 v[192:195], v[100:103], v[92:95], v[192:195]
ds_read_b64 v[84:85], v5 offset:1768
v_mfma_f32_16x16x32_bf16 v[204:207], v[108:111], v[92:95], v[204:207]
ds_read_b64 v[86:87], v5 offset:1776
v_mfma_f32_16x16x32_bf16 v[216:219], v[116:119], v[92:95], v[216:219]
v_mfma_f32_16x16x32_bf16 v[228:231], v[124:127], v[92:95], v[228:231]
v_mfma_f32_16x16x32_bf16 v[240:243], v[132:135], v[92:95], v[240:243]
v_mfma_f32_16x16x32_bf16 v[252:255], v[140:143], v[92:95], v[252:255]
v_mfma_f32_16x16x32_bf16 v[184:187], v[96:99], v[16:19], v[184:187]
ds_read_b64 v[88:89], v5 offset:2952
v_mfma_f32_16x16x32_bf16 v[196:199], v[104:107], v[16:19], v[196:199]
ds_read_b64 v[90:91], v5 offset:2960
v_mfma_f32_16x16x32_bf16 v[208:211], v[112:115], v[16:19], v[208:211]
v_mfma_f32_16x16x32_bf16 v[220:223], v[120:123], v[16:19], v[220:223]
v_mfma_f32_16x16x32_bf16 v[232:235], v[128:131], v[16:19], v[232:235]
v_mfma_f32_16x16x32_bf16 v[244:247], v[136:139], v[16:19], v[244:247]
v_mfma_f32_16x16x32_bf16 v[190:193], v[96:99], v[20:23], v[190:193]
ds_read_b64 v[92:93], v5 offset:4136
v_mfma_f32_16x16x32_bf16 v[202:205], v[104:107], v[20:23], v[202:205]
ds_read_b64 v[94:95], v5 offset:4144
v_mfma_f32_16x16x32_bf16 v[214:217], v[112:115], v[20:23], v[214:217]
v_mfma_f32_16x16x32_bf16 v[226:229], v[120:123], v[20:23], v[226:229]
v_mfma_f32_16x16x32_bf16 v[238:241], v[128:131], v[20:23], v[238:241]
v_mfma_f32_16x16x32_bf16 v[250:253], v[136:139], v[20:23], v[250:253]
v_mfma_f32_16x16x32_bf16 v[186:189], v[96:99], v[24:27], v[186:189]
ds_read_b64 v[16:17], v5 offset:648
v_mfma_f32_16x16x32_bf16 v[198:201], v[104:107], v[24:27], v[198:201]
ds_read_b64 v[18:19], v5 offset:656
v_mfma_f32_16x16x32_bf16 v[210:213], v[112:115], v[24:27], v[210:213]
v_mfma_f32_16x16x32_bf16 v[222:225], v[120:123], v[24:27], v[222:225]
v_mfma_f32_16x16x32_bf16 v[234:237], v[128:131], v[24:27], v[234:237]
v_mfma_f32_16x16x32_bf16 v[246:249], v[136:139], v[24:27], v[246:249]
v_mfma_f32_16x16x32_bf16 v[192:195], v[96:99], v[28:31], v[192:195]
ds_read_b64 v[20:21], v5 offset:1832
v_mfma_f32_16x16x32_bf16 v[204:207], v[104:107], v[28:31], v[204:207]
ds_read_b64 v[22:23], v5 offset:1840
v_mfma_f32_16x16x32_bf16 v[216:219], v[112:115], v[28:31], v[216:219]
v_mfma_f32_16x16x32_bf16 v[228:231], v[120:123], v[28:31], v[228:231]
v_mfma_f32_16x16x32_bf16 v[240:243], v[128:131], v[28:31], v[240:243]
v_mfma_f32_16x16x32_bf16 v[252:255], v[136:139], v[28:31], v[252:255]
v_mfma_f32_16x16x32_bf16 v[196:199], v[100:103], v[32:35], v[196:199]
v_add_f32 v185, v185, v190
v_add_f32 v186, v186, v191
v_mfma_f32_16x16x32_bf16 v[208:211], v[108:111], v[32:35], v[208:211]
v_add_f32 v187, v187, v192
v_add_f32 v193, v193, v188
v_mfma_f32_16x16x32_bf16 v[220:223], v[116:119], v[32:35], v[220:223]
ds_write_b128 v2, v[184:187] offset:10496
v_mfma_f32_16x16x32_bf16 v[232:235], v[124:127], v[32:35], v[232:235]
v_add_f32 v194, v194, v189
v_mov_b32 v192, 0
v_mfma_f32_16x16x32_bf16 v[244:247], v[132:135], v[32:35], v[244:247]
ds_write_b128 v6, v[192:195] offset:2048
v_mfma_f32_16x16x32_bf16 v[202:205], v[100:103], v[36:39], v[202:205]
ds_read_b64 v[24:25], v5 offset:3016
v_mfma_f32_16x16x32_bf16 v[214:217], v[108:111], v[36:39], v[214:217]
ds_read_b64 v[26:27], v5 offset:3024
v_mfma_f32_16x16x32_bf16 v[226:229], v[116:119], v[36:39], v[226:229]
ds_read_b64 v[28:29], v5 offset:4200
v_mfma_f32_16x16x32_bf16 v[238:241], v[124:127], v[36:39], v[238:241]
ds_read_b64 v[30:31], v5 offset:4208
v_mfma_f32_16x16x32_bf16 v[250:253], v[132:135], v[36:39], v[250:253]
v_mfma_f32_16x16x32_bf16 v[198:201], v[100:103], v[40:43], v[198:201]
s_waitcnt lgkmcnt(4)
s_barrier
v_mfma_f32_16x16x32_bf16 v[210:213], v[108:111], v[40:43], v[210:213]
ds_read_b64 v[32:33], v5 offset:712
v_mfma_f32_16x16x32_bf16 v[222:225], v[116:119], v[40:43], v[222:225]
ds_read_b64 v[34:35], v5 offset:720
v_mfma_f32_16x16x32_bf16 v[234:237], v[124:127], v[40:43], v[234:237]
v_mfma_f32_16x16x32_bf16 v[246:249], v[132:135], v[40:43], v[246:249]
v_mfma_f32_16x16x32_bf16 v[204:207], v[100:103], v[44:47], v[204:207]
ds_read_b64 v[36:37], v5 offset:1896
v_mfma_f32_16x16x32_bf16 v[216:219], v[108:111], v[44:47], v[216:219]
ds_read_b64 v[38:39], v5 offset:1904
v_mfma_f32_16x16x32_bf16 v[228:231], v[116:119], v[44:47], v[228:231]
v_mfma_f32_16x16x32_bf16 v[240:243], v[124:127], v[44:47], v[240:243]
v_mfma_f32_16x16x32_bf16 v[252:255], v[132:135], v[44:47], v[252:255]
v_mfma_f32_16x16x32_bf16 v[196:199], v[96:99], v[48:51], v[196:199]
ds_read_b64 v[40:41], v5 offset:3080
v_mfma_f32_16x16x32_bf16 v[208:211], v[104:107], v[48:51], v[208:211]
ds_read_b64 v[42:43], v5 offset:3088
v_mfma_f32_16x16x32_bf16 v[220:223], v[112:115], v[48:51], v[220:223]
v_mfma_f32_16x16x32_bf16 v[232:235], v[120:123], v[48:51], v[232:235]
v_mfma_f32_16x16x32_bf16 v[244:247], v[128:131], v[48:51], v[244:247]
v_mfma_f32_16x16x32_bf16 v[202:205], v[96:99], v[52:55], v[202:205]
ds_read_b64 v[44:45], v5 offset:4264
v_mfma_f32_16x16x32_bf16 v[214:217], v[104:107], v[52:55], v[214:217]
ds_read_b64 v[46:47], v5 offset:4272
v_mfma_f32_16x16x32_bf16 v[226:229], v[112:115], v[52:55], v[226:229]
v_mfma_f32_16x16x32_bf16 v[238:241], v[120:123], v[52:55], v[238:241]
v_mfma_f32_16x16x32_bf16 v[250:253], v[128:131], v[52:55], v[250:253]
v_mfma_f32_16x16x32_bf16 v[198:201], v[96:99], v[56:59], v[198:201]
ds_read_b64 v[48:49], v5 offset:776
v_mfma_f32_16x16x32_bf16 v[210:213], v[104:107], v[56:59], v[210:213]
ds_read_b64 v[50:51], v5 offset:784
v_mfma_f32_16x16x32_bf16 v[222:225], v[112:115], v[56:59], v[222:225]
v_mfma_f32_16x16x32_bf16 v[234:237], v[120:123], v[56:59], v[234:237]
v_mfma_f32_16x16x32_bf16 v[246:249], v[128:131], v[56:59], v[246:249]
v_mfma_f32_16x16x32_bf16 v[204:207], v[96:99], v[60:63], v[204:207]
ds_read_b64 v[52:53], v5 offset:1960
v_mfma_f32_16x16x32_bf16 v[216:219], v[104:107], v[60:63], v[216:219]
ds_read_b64 v[54:55], v5 offset:1968
v_mfma_f32_16x16x32_bf16 v[228:231], v[112:115], v[60:63], v[228:231]
v_mfma_f32_16x16x32_bf16 v[240:243], v[120:123], v[60:63], v[240:243]
v_mfma_f32_16x16x32_bf16 v[252:255], v[128:131], v[60:63], v[252:255]
v_mfma_f32_16x16x32_bf16 v[208:211], v[100:103], v[64:67], v[208:211]
v_add_f32 v197, v197, v202
v_add_f32 v198, v198, v203
v_mfma_f32_16x16x32_bf16 v[220:223], v[108:111], v[64:67], v[220:223]
v_add_f32 v199, v199, v204
v_add_f32 v205, v205, v200
v_mfma_f32_16x16x32_bf16 v[232:235], v[116:119], v[64:67], v[232:235]
ds_write_b128 v2, v[196:199] offset:11520
v_mfma_f32_16x16x32_bf16 v[244:247], v[124:127], v[64:67], v[244:247]
v_add_f32 v206, v206, v201
v_mov_b32 v204, 0
v_mfma_f32_16x16x32_bf16 v[214:217], v[100:103], v[68:71], v[214:217]
ds_write_b128 v6, v[204:207] offset:3072
v_mfma_f32_16x16x32_bf16 v[226:229], v[108:111], v[68:71], v[226:229]
ds_read_b64 v[56:57], v5 offset:3144
v_mfma_f32_16x16x32_bf16 v[238:241], v[116:119], v[68:71], v[238:241]
ds_read_b64 v[58:59], v5 offset:3152
v_mfma_f32_16x16x32_bf16 v[250:253], v[124:127], v[68:71], v[250:253]
ds_read_b64 v[60:61], v5 offset:4328
v_mfma_f32_16x16x32_bf16 v[210:213], v[100:103], v[72:75], v[210:213]
ds_read_b64 v[62:63], v5 offset:4336
v_mfma_f32_16x16x32_bf16 v[222:225], v[108:111], v[72:75], v[222:225]
ds_read_b64 v[64:65], v5 offset:840
v_mfma_f32_16x16x32_bf16 v[234:237], v[116:119], v[72:75], v[234:237]
s_waitcnt lgkmcnt(5)
s_barrier
v_mfma_f32_16x16x32_bf16 v[246:249], v[124:127], v[72:75], v[246:249]
ds_read_b64 v[66:67], v5 offset:848
v_mfma_f32_16x16x32_bf16 v[216:219], v[100:103], v[76:79], v[216:219]
ds_read_b64 v[68:69], v5 offset:2024
v_mfma_f32_16x16x32_bf16 v[228:231], v[108:111], v[76:79], v[228:231]
ds_read_b64 v[70:71], v5 offset:2032
v_mfma_f32_16x16x32_bf16 v[240:243], v[116:119], v[76:79], v[240:243]
v_mfma_f32_16x16x32_bf16 v[252:255], v[124:127], v[76:79], v[252:255]
v_mfma_f32_16x16x32_bf16 v[208:211], v[96:99], v[80:83], v[208:211]
ds_read_b64 v[72:73], v5 offset:3208
v_mfma_f32_16x16x32_bf16 v[220:223], v[104:107], v[80:83], v[220:223]
ds_read_b64 v[74:75], v5 offset:3216
v_mfma_f32_16x16x32_bf16 v[232:235], v[112:115], v[80:83], v[232:235]
v_mfma_f32_16x16x32_bf16 v[244:247], v[120:123], v[80:83], v[244:247]
v_mfma_f32_16x16x32_bf16 v[214:217], v[96:99], v[84:87], v[214:217]
ds_read_b64 v[76:77], v5 offset:4392
v_mfma_f32_16x16x32_bf16 v[226:229], v[104:107], v[84:87], v[226:229]
ds_read_b64 v[78:79], v5 offset:4400
v_mfma_f32_16x16x32_bf16 v[238:241], v[112:115], v[84:87], v[238:241]
v_mfma_f32_16x16x32_bf16 v[250:253], v[120:123], v[84:87], v[250:253]
v_mfma_f32_16x16x32_bf16 v[210:213], v[96:99], v[88:91], v[210:213]
ds_read_b64 v[80:81], v5 offset:904
v_mfma_f32_16x16x32_bf16 v[222:225], v[104:107], v[88:91], v[222:225]
ds_read_b64 v[82:83], v5 offset:912
v_mfma_f32_16x16x32_bf16 v[234:237], v[112:115], v[88:91], v[234:237]
v_mfma_f32_16x16x32_bf16 v[246:249], v[120:123], v[88:91], v[246:249]
v_mfma_f32_16x16x32_bf16 v[216:219], v[96:99], v[92:95], v[216:219]
ds_read_b64 v[84:85], v5 offset:2088
v_mfma_f32_16x16x32_bf16 v[228:231], v[104:107], v[92:95], v[228:231]
ds_read_b64 v[86:87], v5 offset:2096
v_mfma_f32_16x16x32_bf16 v[240:243], v[112:115], v[92:95], v[240:243]
v_mfma_f32_16x16x32_bf16 v[252:255], v[120:123], v[92:95], v[252:255]
v_mfma_f32_16x16x32_bf16 v[220:223], v[100:103], v[16:19], v[220:223]
ds_read_b64 v[88:89], v5 offset:3272
v_mfma_f32_16x16x32_bf16 v[232:235], v[108:111], v[16:19], v[232:235]
v_add_f32 v209, v209, v214
v_add_f32 v210, v210, v215
v_mfma_f32_16x16x32_bf16 v[244:247], v[116:119], v[16:19], v[244:247]
v_add_f32 v211, v211, v216
v_add_f32 v217, v217, v212
v_mfma_f32_16x16x32_bf16 v[226:229], v[100:103], v[20:23], v[226:229]
ds_write_b128 v2, v[208:211] offset:8448
v_mfma_f32_16x16x32_bf16 v[238:241], v[108:111], v[20:23], v[238:241]
v_add_f32 v218, v218, v213
v_mov_b32 v216, 0
v_mfma_f32_16x16x32_bf16 v[250:253], v[116:119], v[20:23], v[250:253]
ds_write_b128 v6, v[216:219] offset:4096
v_mfma_f32_16x16x32_bf16 v[222:225], v[100:103], v[24:27], v[222:225]
ds_read_b64 v[90:91], v5 offset:3280
v_mfma_f32_16x16x32_bf16 v[234:237], v[108:111], v[24:27], v[234:237]
ds_read_b64 v[92:93], v5 offset:4456
v_mfma_f32_16x16x32_bf16 v[246:249], v[116:119], v[24:27], v[246:249]
ds_read_b64 v[94:95], v5 offset:4464
v_mfma_f32_16x16x32_bf16 v[228:231], v[100:103], v[28:31], v[228:231]
ds_read_b64 v[16:17], v5 offset:968
v_mfma_f32_16x16x32_bf16 v[240:243], v[108:111], v[28:31], v[240:243]
ds_read_b64 v[18:19], v5 offset:976
v_mfma_f32_16x16x32_bf16 v[252:255], v[116:119], v[28:31], v[252:255]
s_waitcnt lgkmcnt(5)
s_barrier
v_mfma_f32_16x16x32_bf16 v[220:223], v[96:99], v[32:35], v[220:223]
ds_read_b64 v[20:21], v5 offset:2152
v_mfma_f32_16x16x32_bf16 v[232:235], v[104:107], v[32:35], v[232:235]
ds_read_b64 v[22:23], v5 offset:2160
v_mfma_f32_16x16x32_bf16 v[244:247], v[112:115], v[32:35], v[244:247]
ds_read_b64 v[24:25], v5 offset:3336
v_mfma_f32_16x16x32_bf16 v[226:229], v[96:99], v[36:39], v[226:229]
ds_read_b64 v[26:27], v5 offset:3344
v_mfma_f32_16x16x32_bf16 v[238:241], v[104:107], v[36:39], v[238:241]
ds_read_b64 v[28:29], v5 offset:4520
v_mfma_f32_16x16x32_bf16 v[250:253], v[112:115], v[36:39], v[250:253]
ds_read_b64 v[30:31], v5 offset:4528
v_mfma_f32_16x16x32_bf16 v[222:225], v[96:99], v[40:43], v[222:225]
v_mfma_f32_16x16x32_bf16 v[234:237], v[104:107], v[40:43], v[234:237]
v_mfma_f32_16x16x32_bf16 v[246:249], v[112:115], v[40:43], v[246:249]
v_mfma_f32_16x16x32_bf16 v[228:231], v[96:99], v[44:47], v[228:231]
v_mfma_f32_16x16x32_bf16 v[240:243], v[104:107], v[44:47], v[240:243]
v_mfma_f32_16x16x32_bf16 v[252:255], v[112:115], v[44:47], v[252:255]
s_nop 1
v_mfma_f32_16x16x32_bf16 v[232:235], v[100:103], v[48:51], v[232:235]
v_mfma_f32_16x16x32_bf16 v[244:247], v[108:111], v[48:51], v[244:247]
s_nop 0
v_mfma_f32_16x16x32_bf16 v[238:241], v[100:103], v[52:55], v[238:241]
v_add_f32 v221, v221, v226
v_add_f32 v222, v222, v227
v_mfma_f32_16x16x32_bf16 v[250:253], v[108:111], v[52:55], v[250:253]
v_add_f32 v223, v223, v228
v_add_f32 v229, v229, v224
v_mfma_f32_16x16x32_bf16 v[234:237], v[100:103], v[56:59], v[234:237]
ds_write_b128 v2, v[220:223] offset:9472
v_mfma_f32_16x16x32_bf16 v[246:249], v[108:111], v[56:59], v[246:249]
v_add_f32 v230, v230, v225
v_mov_b32 v228, 0
v_mfma_f32_16x16x32_bf16 v[240:243], v[100:103], v[60:63], v[240:243]
ds_write_b128 v6, v[228:231] offset:5120
v_mfma_f32_16x16x32_bf16 v[252:255], v[108:111], v[60:63], v[252:255]
v_mfma_f32_16x16x32_bf16 v[232:235], v[96:99], v[64:67], v[232:235]
v_mfma_f32_16x16x32_bf16 v[244:247], v[104:107], v[64:67], v[244:247]
s_nop 1
v_mfma_f32_16x16x32_bf16 v[238:241], v[96:99], v[68:71], v[238:241]
s_nop 0
v_mfma_f32_16x16x32_bf16 v[250:253], v[104:107], v[68:71], v[250:253]
v_mfma_f32_16x16x32_bf16 v[234:237], v[96:99], v[72:75], v[234:237]
s_waitcnt lgkmcnt(0)
s_barrier
v_mfma_f32_16x16x32_bf16 v[246:249], v[104:107], v[72:75], v[246:249]
v_mfma_f32_16x16x32_bf16 v[240:243], v[96:99], v[76:79], v[240:243]
s_nop 0
v_mfma_f32_16x16x32_bf16 v[252:255], v[104:107], v[76:79], v[252:255]
s_nop 2
v_mfma_f32_16x16x32_bf16 v[244:247], v[100:103], v[80:83], v[244:247]
s_nop 1
v_mfma_f32_16x16x32_bf16 v[250:253], v[100:103], v[84:87], v[250:253]
s_nop 2
v_mfma_f32_16x16x32_bf16 v[246:249], v[100:103], v[88:91], v[246:249]
s_nop 1
v_mfma_f32_16x16x32_bf16 v[252:255], v[100:103], v[92:95], v[252:255]
v_add_f32 v233, v233, v238
v_add_f32 v234, v234, v239
s_nop 0
v_mfma_f32_16x16x32_bf16 v[244:247], v[96:99], v[16:19], v[244:247]
v_add_f32 v235, v235, v240
v_add_f32 v241, v241, v236
v_mfma_f32_16x16x32_bf16 v[250:253], v[96:99], v[20:23], v[250:253]
ds_write_b128 v2, v[232:235] offset:10496
s_nop 1
v_mfma_f32_16x16x32_bf16 v[246:249], v[96:99], v[24:27], v[246:249]
v_add_f32 v242, v242, v237
v_mov_b32 v240, 0
v_mfma_f32_16x16x32_bf16 v[252:255], v[96:99], v[28:31], v[252:255]
ds_write_b128 v6, v[240:243] offset:6144
s_waitcnt lgkmcnt(0)
s_barrier
v_add_f32 v245, v245, v250
s_nop 0
v_add_f32 v246, v246, v251
s_nop 1
v_add_f32 v247, v247, v252
v_add_f32 v253, v253, v248
ds_write_b128 v2, v[244:247] offset:11520
v_add_f32 v254, v254, v249
v_mov_b32 v252, 0
ds_write_b128 v6, v[252:255] offset:7168
s_waitcnt lgkmcnt(0)
s_barrier
s_branch LA_end
LA_help:
s_mov_b32 s8, s36
s_mov_b32 s9, s37
s_mov_b32 s10, 5242880
s_mov_b32 s11, 0x20000
s_cmp_eq_u32 s63, 0
s_cbranch_scc1 LA_hout
s_waitcnt vmcnt(0)
ds_write_b128 v12, v[140:143] offset:128
ds_write_b128 v12, v[144:147] offset:9600
s_waitcnt lgkmcnt(0)
s_barrier
s_lshl_b32 s50, s63, 3
s_add_u32 s50, s50, s3
s_cmp_lg_u32 s50, 15
s_cbranch_scc1 LA_hout
s_sub_u32 s94, s45, 24
s_mov_b32 s12, s34
s_mov_b32 s13, s35
s_mov_b32 s14, 819200
s_mov_b32 s15, 0x20000
s_lshr_b32 s60, s94, 1
s_mul_i32 s60, s60, 102400
s_mul_i32 s50, s94, 51200
s_add_u32 s60, s60, s50
v_lshlrev_b32 v158, 7, v1
buffer_load_dword v160, v158, s[12:15], s60 offen
s_add_u32 s60, s60, 8192
buffer_load_dword v161, v158, s[12:15], s60 offen
s_add_u32 s60, s60, 8192
buffer_load_dword v162, v158, s[12:15], s60 offen
s_add_u32 s60, s60, 8192
buffer_load_dword v163, v158, s[12:15], s60 offen
s_add_u32 s60, s60, 8192
buffer_load_dword v164, v158, s[12:15], s60 offen
s_add_u32 s60, s60, 8192
buffer_load_dword v165, v158, s[12:15], s60 offen
s_add_u32 s60, s60, 2048
buffer_load_dword v166, v158, s[12:15], s60 offen
s_add_u32 s60, s60, 366592
s_mul_i32 s92, s44, 48
s_mul_i32 s93, s94, 6
s_add_u32 s92, s92, s93
s_add_u32 s92, s92, 256
s_lshl_b32 s92, s92, 8
v_min_u32 v152, 11, v1
v_lshlrev_b32 v152, 7, v152
v_add_u32 v152, s92, v152
global_load_dword v168, v152, s[18:19]
global_load_dword v169, v152, s[20:21]
global_load_dword v170, v152, s[22:23]
global_load_dword v171, v152, s[24:25]
LA_hout:
s_sub_u32 s95, s45, 12
v_bfe_u32 v154, v1, 2, 2
v_lshrrev_b32 v155, 5, v1
v_xor_b32 v154, v154, v155
v_lshlrev_b32 v154, 6, v154
v_and_b32 v155, 3, v1
v_lshl_add_u32 v154, v155, 4, v154
v_lshrrev_b32 v155, 4, v1
v_mul_u32_u24 v155, 1280, v155
v_add_u32 v152, v154, v155
v_xor_b32 v153, 128, v152
s_lshr_b32 s92, s95, 2
s_lshl_b32 s92, s92, 8
s_sub_u32 s93, s3, 4
s_mul_i32 s94, s93, 204800
s_add_u32 s92, s92, s94
s_mul_i32 s94, s93, 20480
s_add_u32 s94, s94, 81920
s_mov_b32 s96, s34
s_mov_b32 s97, s35
s_mov_b32 s98, 819200
s_mov_b32 s99, 0x20000
s_barrier
ds_read_b32 v24, v5 offset:8448
ds_read_b32 v28, v5 offset:4
ds_read_b32 v25, v5 offset:24864
ds_read_b32 v29, v5 offset:16420
ds_read_b32 v26, v5 offset:41280
ds_read_b32 v30, v5 offset:32836
ds_read_b32 v27, v5 offset:57696
ds_read_b32 v31, v5 offset:49252
s_waitcnt lgkmcnt(6)
v_add_f32 v24, v24, v28
s_waitcnt lgkmcnt(4)
v_add_f32 v25, v25, v29
v_cvt_pk_bf16_f32 v32, v24, v25
s_waitcnt lgkmcnt(2)
v_add_f32 v26, v26, v30
s_waitcnt lgkmcnt(0)
v_add_f32 v27, v27, v31
v_cvt_pk_bf16_f32 v33, v26, v27
buffer_store_dwordx2 v[32:33], v7, s[8:11], s62 offen
s_add_u32 s62, s62, 655360
s_barrier
ds_read_b32 v34, v5 offset:9472
ds_read_b32 v38, v5 offset:1028
ds_read_b32 v35, v5 offset:25888
ds_read_b32 v39, v5 offset:17444
ds_read_b32 v36, v5 offset:42304
ds_read_b32 v40, v5 offset:33860
ds_read_b32 v37, v5 offset:58720
ds_read_b32 v41, v5 offset:50276
s_waitcnt lgkmcnt(6)
v_add_f32 v34, v34, v38
s_waitcnt lgkmcnt(4)
v_add_f32 v35, v35, v39
v_cvt_pk_bf16_f32 v42, v34, v35
s_waitcnt lgkmcnt(2)
v_add_f32 v36, v36, v40
s_waitcnt lgkmcnt(0)
v_add_f32 v37, v37, v41
v_cvt_pk_bf16_f32 v43, v36, v37
buffer_store_dwordx2 v[42:43], v7, s[8:11], s62 offen
s_add_u32 s62, s62, 655360
s_cmp_eq_u32 s63, 0
s_cbranch_scc1 LA_hw1
s_add_u32 m0, s94, 0
s_add_u32 s93, s92, 0
buffer_load_dwordx4 v152, s[96:99], s93 offen lds
s_add_u32 m0, s94, 1024
s_add_u32 s93, s92, 5120
buffer_load_dwordx4 v153, s[96:99], s93 offen lds
s_add_u32 m0, s94, 2048
s_add_u32 s93, s92, 10240
buffer_load_dwordx4 v152, s[96:99], s93 offen lds
s_add_u32 m0, s94, 3072
s_add_u32 s93, s92, 15360
buffer_load_dwordx4 v153, s[96:99], s93 offen lds
s_add_u32 m0, s94, 4096
s_add_u32 s93, s92, 20480
buffer_load_dwordx4 v152, s[96:99], s93 offen lds
LA_hw1:
s_barrier
ds_read_b32 v24, v5 offset:10496
ds_read_b32 v28, v5 offset:2052
ds_read_b32 v25, v5 offset:26912
ds_read_b32 v29, v5 offset:18468
ds_read_b32 v26, v5 offset:43328
ds_read_b32 v30, v5 offset:34884
ds_read_b32 v27, v5 offset:59744
ds_read_b32 v31, v5 offset:51300
s_waitcnt lgkmcnt(6)
v_add_f32 v24, v24, v28
s_waitcnt lgkmcnt(4)
v_add_f32 v25, v25, v29
v_cvt_pk_bf16_f32 v32, v24, v25
s_waitcnt lgkmcnt(2)
v_add_f32 v26, v26, v30
s_waitcnt lgkmcnt(0)
v_add_f32 v27, v27, v31
v_cvt_pk_bf16_f32 v33, v26, v27
buffer_store_dwordx2 v[32:33], v7, s[8:11], s62 offen
s_add_u32 s62, s62, 655360
s_cmp_eq_u32 s63, 0
s_cbranch_scc1 LA_hw2
s_add_u32 m0, s94, 5120
s_add_u32 s93, s92, 25600
buffer_load_dwordx4 v153, s[96:99], s93 offen lds
s_add_u32 m0, s94, 6144
s_add_u32 s93, s92, 30720
buffer_load_dwordx4 v152, s[96:99], s93 offen lds
s_add_u32 m0, s94, 7168
s_add_u32 s93, s92, 35840
buffer_load_dwordx4 v153, s[96:99], s93 offen lds
s_add_u32 m0, s94, 8192
s_add_u32 s93, s92, 40960
buffer_load_dwordx4 v152, s[96:99], s93 offen lds
s_add_u32 m0, s94, 9216
s_add_u32 s93, s92, 46080
buffer_load_dwordx4 v153, s[96:99], s93 offen lds
LA_hw2:
s_barrier
ds_read_b32 v34, v5 offset:11520
ds_read_b32 v38, v5 offset:3076
ds_read_b32 v35, v5 offset:27936
ds_read_b32 v39, v5 offset:19492
ds_read_b32 v36, v5 offset:44352
ds_read_b32 v40, v5 offset:35908
ds_read_b32 v37, v5 offset:60768
ds_read_b32 v41, v5 offset:52324
s_waitcnt lgkmcnt(6)
v_add_f32 v34, v34, v38
s_waitcnt lgkmcnt(4)
v_add_f32 v35, v35, v39
v_cvt_pk_bf16_f32 v42, v34, v35
s_waitcnt lgkmcnt(2)
v_add_f32 v36, v36, v40
s_waitcnt lgkmcnt(0)
v_add_f32 v37, v37, v41
v_cvt_pk_bf16_f32 v43, v36, v37
buffer_store_dwordx2 v[42:43], v7, s[8:11], s62 offen
s_add_u32 s62, s62, 655360
s_cmp_eq_u32 s63, 0
s_cbranch_scc1 LA_hw3
s_add_u32 m0, s94, 10240
s_add_u32 s93, s92, 51200
buffer_load_dwordx4 v152, s[96:99], s93 offen lds
s_add_u32 m0, s94, 11264
s_add_u32 s93, s92, 56320
buffer_load_dwordx4 v153, s[96:99], s93 offen lds
s_add_u32 m0, s94, 12288
s_add_u32 s93, s92, 61440
buffer_load_dwordx4 v152, s[96:99], s93 offen lds
s_add_u32 m0, s94, 13312
s_add_u32 s93, s92, 66560
buffer_load_dwordx4 v153, s[96:99], s93 offen lds
s_add_u32 m0, s94, 14336
s_add_u32 s93, s92, 71680
buffer_load_dwordx4 v152, s[96:99], s93 offen lds
LA_hw3:
s_barrier
ds_read_b32 v24, v5 offset:8448
ds_read_b32 v28, v5 offset:4100
ds_read_b32 v25, v5 offset:24864
ds_read_b32 v29, v5 offset:20516
ds_read_b32 v26, v5 offset:41280
ds_read_b32 v30, v5 offset:36932
ds_read_b32 v27, v5 offset:57696
ds_read_b32 v31, v5 offset:53348
s_waitcnt lgkmcnt(6)
v_add_f32 v24, v24, v28
s_waitcnt lgkmcnt(4)
v_add_f32 v25, v25, v29
v_cvt_pk_bf16_f32 v32, v24, v25
s_waitcnt lgkmcnt(2)
v_add_f32 v26, v26, v30
s_waitcnt lgkmcnt(0)
v_add_f32 v27, v27, v31
v_cvt_pk_bf16_f32 v33, v26, v27
buffer_store_dwordx2 v[32:33], v7, s[8:11], s62 offen
s_add_u32 s62, s62, 655360
s_cmp_eq_u32 s63, 0
s_cbranch_scc1 LA_hw4
s_add_u32 m0, s94, 15360
s_add_u32 s93, s92, 76800
buffer_load_dwordx4 v153, s[96:99], s93 offen lds
s_add_u32 m0, s94, 16384
s_add_u32 s93, s92, 81920
buffer_load_dwordx4 v152, s[96:99], s93 offen lds
s_add_u32 m0, s94, 17408
s_add_u32 s93, s92, 87040
buffer_load_dwordx4 v153, s[96:99], s93 offen lds
s_add_u32 m0, s94, 18432
s_add_u32 s93, s92, 92160
buffer_load_dwordx4 v152, s[96:99], s93 offen lds
s_add_u32 m0, s94, 19456
s_add_u32 s93, s92, 97280
buffer_load_dwordx4 v153, s[96:99], s93 offen lds
LA_hw4:
s_barrier
ds_read_b32 v34, v5 offset:9472
ds_read_b32 v38, v5 offset:5124
ds_read_b32 v35, v5 offset:25888
ds_read_b32 v39, v5 offset:21540
ds_read_b32 v36, v5 offset:42304
ds_read_b32 v40, v5 offset:37956
ds_read_b32 v37, v5 offset:58720
ds_read_b32 v41, v5 offset:54372
s_waitcnt lgkmcnt(6)
v_add_f32 v34, v34, v38
s_waitcnt lgkmcnt(4)
v_add_f32 v35, v35, v39
v_cvt_pk_bf16_f32 v42, v34, v35
s_waitcnt lgkmcnt(2)
v_add_f32 v36, v36, v40
s_waitcnt lgkmcnt(0)
v_add_f32 v37, v37, v41
v_cvt_pk_bf16_f32 v43, v36, v37
buffer_store_dwordx2 v[42:43], v7, s[8:11], s62 offen
s_add_u32 s62, s62, 655360
s_barrier
ds_read_b32 v24, v5 offset:10496
ds_read_b32 v28, v5 offset:6148
ds_read_b32 v25, v5 offset:26912
ds_read_b32 v29, v5 offset:22564
ds_read_b32 v26, v5 offset:43328
ds_read_b32 v30, v5 offset:38980
ds_read_b32 v27, v5 offset:59744
ds_read_b32 v31, v5 offset:55396
s_waitcnt lgkmcnt(6)
v_add_f32 v24, v24, v28
s_waitcnt lgkmcnt(4)
v_add_f32 v25, v25, v29
v_cvt_pk_bf16_f32 v32, v24, v25
s_waitcnt lgkmcnt(2)
v_add_f32 v26, v26, v30
s_waitcnt lgkmcnt(0)
v_add_f32 v27, v27, v31
v_cvt_pk_bf16_f32 v33, v26, v27
buffer_store_dwordx2 v[32:33], v7, s[8:11], s62 offen
s_add_u32 s62, s62, 655360
s_barrier
ds_read_b32 v34, v5 offset:11520
ds_read_b32 v38, v5 offset:7172
ds_read_b32 v35, v5 offset:27936
ds_read_b32 v39, v5 offset:23588
ds_read_b32 v36, v5 offset:44352
ds_read_b32 v40, v5 offset:40004
ds_read_b32 v37, v5 offset:60768
ds_read_b32 v41, v5 offset:56420
s_waitcnt lgkmcnt(6)
v_add_f32 v34, v34, v38
s_waitcnt lgkmcnt(4)
v_add_f32 v35, v35, v39
v_cvt_pk_bf16_f32 v42, v34, v35
s_waitcnt lgkmcnt(2)
v_add_f32 v36, v36, v40
s_waitcnt lgkmcnt(0)
v_add_f32 v37, v37, v41
v_cvt_pk_bf16_f32 v43, v36, v37
buffer_store_dwordx2 v[42:43], v7, s[8:11], s62 offen
LA_end:
s_cmp_eq_u32 s63, 1
s_cbranch_scc1 LA_end1
s_endpgm
LA_end1:
s_sub_u32 s45, s45, 12
s_mov_b32 s63, 0
s_mov_b32 s66, 0
s_branch LG2
LA2:
s_mov_b32 s63, 0
s_branch LA
LT_fin:
s_add_u32 s93, s52, 4223
s_and_b32 s93, s93, 0xffffff80
v_lshlrev_b32 v156, 12, v153
v_lshl_add_u32 v156, v152, 4, v156
v_xor_b32 v154, v152, v153
v_lshlrev_b32 v154, 4, v154
v_lshl_add_u32 v154, v152, 10, v154
v_add_u32 v154, s93, v154
v_lshlrev_b32 v155, 4, v1
v_add_u32 v155, s93, v155
s_add_u32 s96, s40, 4194304
s_addc_u32 s97, s41, 0
s_mov_b32 s98, 2621440
s_mov_b32 s99, 0x20000
s_lshl_b32 s92, s94, 18
s_lshl_b32 s93, s95, 7
s_add_u32 s92, s92, s93
s_mov_b32 s100, 0x05040100
s_mov_b32 s101, 0x07060302
v_perm_b32 v192, v164, v160, s100
v_perm_b32 v196, v164, v160, s101
v_perm_b32 v200, v165, v161, s100
v_perm_b32 v204, v165, v161, s101
v_perm_b32 v208, v166, v162, s100
v_perm_b32 v212, v166, v162, s101
v_perm_b32 v216, v167, v163, s100
v_perm_b32 v220, v167, v163, s101
v_perm_b32 v193, v172, v168, s100
v_perm_b32 v197, v172, v168, s101
v_perm_b32 v201, v173, v169, s100
v_perm_b32 v205, v173, v169, s101
v_perm_b32 v209, v174, v170, s100
v_perm_b32 v213, v174, v170, s101
v_perm_b32 v217, v175, v171, s100
v_perm_b32 v221, v175, v171, s101
v_perm_b32 v194, v180, v176, s100
v_perm_b32 v198, v180, v176, s101
v_perm_b32 v202, v181, v177, s100
v_perm_b32 v206, v181, v177, s101
v_perm_b32 v210, v182, v178, s100
v_perm_b32 v214, v182, v178, s101
v_perm_b32 v218, v183, v179, s100
v_perm_b32 v222, v183, v179, s101
v_perm_b32 v195, v188, v184, s100
v_perm_b32 v199, v188, v184, s101
v_perm_b32 v203, v189, v185, s100
v_perm_b32 v207, v189, v185, s101
v_perm_b32 v211, v190, v186, s100
v_perm_b32 v215, v190, v186, s101
v_perm_b32 v219, v191, v187, s100
v_perm_b32 v223, v191, v187, s101
ds_write_b128 v154, v[192:195] offset:0
ds_write_b128 v154, v[196:199] offset:128
ds_write_b128 v154, v[200:203] offset:256
ds_write_b128 v154, v[204:207] offset:384
ds_write_b128 v154, v[208:211] offset:512
ds_write_b128 v154, v[212:215] offset:640
ds_write_b128 v154, v[216:219] offset:768
ds_write_b128 v154, v[220:223] offset:896
v_xor_b32 v157, 0, v155
ds_read_b128 v[160:163], v157 offset:0
v_xor_b32 v157, 16, v155
ds_read_b128 v[164:167], v157 offset:1024
v_xor_b32 v157, 32, v155
ds_read_b128 v[168:171], v157 offset:2048
v_xor_b32 v157, 48, v155
ds_read_b128 v[172:175], v157 offset:3072
v_xor_b32 v157, 64, v155
ds_read_b128 v[176:179], v157 offset:4096
v_xor_b32 v157, 80, v155
ds_read_b128 v[180:183], v157 offset:5120
v_xor_b32 v157, 96, v155
ds_read_b128 v[184:187], v157 offset:6144
v_xor_b32 v157, 112, v155
ds_read_b128 v[188:191], v157 offset:7168
s_waitcnt lgkmcnt(7)
buffer_store_dwordx4 v[160:163], v156, s[96:99], s92 offen sc1
s_add_u32 s92, s92, 32768
s_waitcnt lgkmcnt(6)
buffer_store_dwordx4 v[164:167], v156, s[96:99], s92 offen sc1
s_add_u32 s92, s92, 32768
s_waitcnt lgkmcnt(5)
buffer_store_dwordx4 v[168:171], v156, s[96:99], s92 offen sc1
s_add_u32 s92, s92, 32768
s_waitcnt lgkmcnt(4)
buffer_store_dwordx4 v[172:175], v156, s[96:99], s92 offen sc1
s_add_u32 s92, s92, 32768
s_waitcnt lgkmcnt(3)
buffer_store_dwordx4 v[176:179], v156, s[96:99], s92 offen sc1
s_add_u32 s92, s92, 32768
s_waitcnt lgkmcnt(2)
buffer_store_dwordx4 v[180:183], v156, s[96:99], s92 offen sc1
s_add_u32 s92, s92, 32768
s_waitcnt lgkmcnt(1)
buffer_store_dwordx4 v[184:187], v156, s[96:99], s92 offen sc1
s_add_u32 s92, s92, 32768
s_waitcnt lgkmcnt(0)
buffer_store_dwordx4 v[188:191], v156, s[96:99], s92 offen sc1
s_setpc_b64 s[64:65]
LT_signal:
s_lshl_b32 s92, s94, 5
s_add_u32 s92, s92, s95
s_lshl_b32 s92, s92, 7
s_add_u32 s92, s92, 3235840
v_mov_b32 v154, s68
v_mov_b32 v155, s69
v_mov_b32 v156, s92
s_mov_b64 exec, 1
global_store_dwordx2 v156, v[154:155], s[40:41] sc1
s_mov_b64 exec, -1
s_setpc_b64 s[64:65]
Lcode_end:
.section .rodata,"a"
.p2align 6
.amdhsa_kernel concat_heads__ssm_conv_s4d__linear_attn_block__prompt_kernel
  .amdhsa_next_free_vgpr 256
  .amdhsa_next_free_sgpr 102
  .amdhsa_accum_offset 256
  .amdhsa_group_segment_fixed_size 0
  .amdhsa_kernarg_size 104
  .amdhsa_user_sgpr_count 2
  .amdhsa_user_sgpr_kernarg_segment_ptr 1
  .amdhsa_system_sgpr_workgroup_id_x 1
.end_amdhsa_kernel
```
